```python
import torch

def _softmax(x, axis=-1):
    return torch.softmax(x, dim=axis)
def _gelu(x):
    return torch.nn.functional.gelu(x, approximate="tanh")
def _silu(x):
    return torch.nn.functional.silu(x)
def _sigmoid(x):
    return torch.sigmoid(x)
def _layernorm(x, axis=-1, eps=1e-5):
    m = x.mean(dim=axis, keepdim=True)
    v = x.var(dim=axis, keepdim=True, unbiased=False)
    return (x - m) / torch.sqrt(v + eps)
def _scatter_add(tgt, idx, src, axis=0):
    return tgt.clone().index_add_(axis, idx, src)
def _segment_sum(src, seg, n):
    out = torch.zeros((n,) + src.shape[1:], dtype=src.dtype)
    return out.index_add_(0, seg, src)
def _pad(x, pw):
    flat = tuple(v for pair in reversed(pw) for v in pair)
    return torch.nn.functional.pad(x, flat)

kernel_name = 'standalone__gqa_block_cached__near_ridge'

def setup_inputs():

    _w = (lambda a: (lambda t: t.to(torch.bfloat16) if t.is_floating_point() else t)(torch.as_tensor(a)))
    B, Sq, D = 8, 48, 1024
    Hq, Hkv, Sk, Dh = 32, 4, 512, 128
    assert Hq % Hkv == 0, (Hq, Hkv)
    return {
        "x": _w((lambda *s: torch.randn(*s, dtype=torch.bfloat16) * 0.8)(B, Sq, D)),
        "k_cache": _w((lambda *s: torch.randn(*s, dtype=torch.bfloat16) * 0.8)(B, Hkv, Sk, Dh)),
        "v_cache": _w((lambda *s: torch.randn(*s, dtype=torch.bfloat16) * 0.05)(B, Hkv, Sk, Dh)),
        "wq": _w((lambda *s: torch.randn(*s, dtype=torch.bfloat16) * 0.8)(D, Hq * Dh) * (D ** -0.5)),
        "wo": _w((lambda *s: torch.randn(*s, dtype=torch.bfloat16) * 0.05)(Hq * Dh, D) * ((Hq * Dh) ** -0.5)),
    }

def reference(x, k_cache, v_cache, wq, wo):
    B, Sq, D = x.shape
    Hq, Dh = 32, 128
    Hkv = k_cache.shape[1]
    rep = Hq // Hkv
    q = (lambda x, *d: x.permute(*d))((x @ wq).reshape(B, Sq, Hq, Dh), 0, 2, 1, 3)
    k = (lambda x, n, axis: torch.repeat_interleave(x, n, dim=axis))(k_cache, rep, axis=1)
    v = (lambda x, n, axis: torch.repeat_interleave(x, n, dim=axis))(v_cache, rep, axis=1)
    scores = torch.einsum("bhqd,bhkd->bhqk", q, k) * (Dh ** -0.5)
    p = _softmax(scores, axis=-1)
    o = torch.einsum("bhqk,bhkd->bhqd", p, v)
    return (lambda x, *d: x.permute(*d))(o, 0, 2, 1, 3).reshape(B, Sq, Hq * Dh) @ wo
```

```asm
; @launch grid=(256,1,1) block=(512,1,1) lds=163840
.amdgcn_target "amdgcn-amd-amdhsa--gfx950"
.text
.globl standalone__gqa_block_cached__near_ridge_kernel
.p2align 8
.type standalone__gqa_block_cached__near_ridge_kernel,@function
standalone__gqa_block_cached__near_ridge_kernel:
    s_load_dwordx2 s[20:21], s[0:1], 0
    s_load_dwordx2 s[24:25], s[0:1], 24
    s_load_dwordx2 s[28:29], s[0:1], 8
    s_load_dwordx2 s[40:41], s[0:1], 56
    s_cmp_ge_u32 s2, 256
    s_cbranch_scc1 L_end
    v_lshrrev_b32 v3, 6, v0
    v_and_b32 v1, 63, v0
    v_readfirstlane_b32 s63, v3
    s_and_b32 s49, s2, 1
    s_bfe_u32 s48, s2, 0x20001
    s_bfe_u32 s51, s2, 0x30003
    s_lshr_b32 s50, s2, 6
    s_and_b32 s52, s63, 3
    s_lshl_b32 s59, s50, 1
    s_add_u32 s53, s59, s49
    s_lshl_b32 s54, s48, 3
    s_add_u32 s54, s54, s51
    s_mul_i32 s56, s52, 3072
    s_lshl_b32 s57, s52, 12
    v_lshrrev_b32 v4, 4, v1
    v_and_b32 v7, 15, v1
    s_cmp_lt_u32 s63, 4
    s_cbranch_scc0 L_compute
    s_lshl_b32 s63, s50, 3
    s_lshr_b32 s58, 0x72d86c78, s63
    s_and_b32 s63, s51, 3
    s_mul_i32 s63, s63, 0x55
    s_xor_b32 s58, s58, s63
    s_xor_b32 s4, s53, 1
    s_mul_i32 s4, s4, 98304
    s_mul_i32 s63, s52, 12
    s_lshl_b32 s64, s49, 10
    v_add_u32 v8, s63, v4
    v_lshl_add_u32 v9, v8, 11, s64
    v_xor_b32 v10, v8, v7
    v_and_b32 v10, 15, v10
    v_lshl_add_u32 v16, v10, 4, v9
    v_add_u32 v8, 4, v8
    v_add_u32 v9, 7168, v9
    v_xor_b32 v10, v8, v7
    v_and_b32 v10, 15, v10
    v_lshl_add_u32 v17, v10, 4, v9
    v_add_u32 v8, 4, v8
    v_add_u32 v9, 7168, v9
    v_xor_b32 v10, v8, v7
    v_and_b32 v10, 15, v10
    v_lshl_add_u32 v18, v10, 4, v9
    s_lshl_b32 s63, s49, 5
    s_add_u32 s63, s63, s52
    s_lshl_b32 s63, s63, 17
    s_lshl_b32 s64, s54, 8
    s_add_u32 s63, s63, s64
    v_lshlrev_b32 v12, 1, v4
    v_xor_b32 v13, v12, v7
    v_lshlrev_b32 v8, 4, v13
    v_lshl_add_u32 v8, v4, 13, v8
    v_add_u32 v19, s63, v8
    v_add_u32 v20, 31744, v19
    v_xor_b32 v9, 128, v19
    v_add_u32 v21, 63488, v9
    v_add_u32 v22, 95232, v9
    s_lshr_b32 s14, 0, s50
    s_and_b32 s14, s14, 1
    s_lshl_b32 s14, s14, 19
    s_xor_b32 s15, s14, 524288
    s_mov_b32 s22, 786432
    s_mov_b32 s23, 0x20000
    s_mov_b32 s26, 8388608
    s_mov_b32 s27, 0x20000
    s_bfe_u32 s60, s58, 0x20000
    s_add_u32 m0, s56, 0
    s_lshl_b32 s61, s60, 8
    s_add_u32 s61, s61, s4
    s_waitcnt lgkmcnt(0)
    buffer_load_dwordx4 v16, s[20:23], s61 offen offset:0 lds
    buffer_load_dwordx4 v17, s[20:23], s61 offen offset:1024 lds
    buffer_load_dwordx4 v18, s[20:23], s61 offen offset:2048 lds
    s_bfe_u32 s60, s58, 0x20000
    s_add_u32 m0, s57, 65536
    s_lshl_b32 s61, s60, 20
    s_add_u32 s61, s61, s14
    buffer_load_dwordx4 v19, s[24:27], s61 offen offset:0 lds
    buffer_load_dwordx4 v20, s[24:27], s61 offen offset:1024 lds
    buffer_load_dwordx4 v21, s[24:27], s61 offen offset:2048 lds
    buffer_load_dwordx4 v22, s[24:27], s61 offen offset:3072 lds
    s_lshl_b32 s62, s53, 2
    s_add_u32 s62, s62, s48
    s_lshl_b32 s62, s62, 17
    s_add_u32 s63, s62, s57
    v_lshlrev_b32 v9, 8, v4
    v_add_u32 v9, s63, v9
    v_xor_b32 v8, v7, v4
    v_lshl_add_u32 v23, v8, 4, v9
    v_xor_b32 v24, 64, v23
    v_xor_b32 v25, 128, v23
    v_xor_b32 v26, 192, v23
    s_mov_b32 s30, 4194304
    s_mov_b32 s31, 0x20000
    s_load_dwordx2 s[32:33], s[0:1], 16
    s_load_dwordx2 s[36:37], s[0:1], 32
    s_mov_b32 s34, 4194304
    s_mov_b32 s35, 0x20000
    s_mov_b32 s38, 8388608
    s_mov_b32 s39, 0x20000
    s_mul_i32 s5, s53, 98304
    s_and_b32 s64, s52, 1
    s_lshl_b32 s63, s64, 13
    s_add_u32 s63, s63, s62
    v_lshrrev_b32 v5, 3, v1
    v_and_b32 v6, 7, v1
    v_xor_b32 v9, v12, v6
    v_lshlrev_b32 v9, 4, v9
    v_lshl_add_u32 v8, v5, 8, v9
    v_add_u32 v36, s63, v8
    s_lshl_b32 s63, s48, 5
    s_add_u32 s63, s63, s64
    s_lshl_b32 s63, s63, 16
    s_lshl_b32 s64, s49, 3
    s_add_u32 s64, s64, s51
    s_lshl_b32 s64, s64, 7
    s_add_u32 s63, s63, s64
    s_mul_i32 s60, s52, 24576
    s_add_u32 s60, s60, s64
    v_min_u32 v8, 11, v1
    v_lshl_add_u32 v42, v8, 11, s60
    v_lshl_add_u32 v9, v5, 11, v9
    v_add_u32 v27, s63, v9
    s_lshr_b32 s64, s52, 1
    s_add_u32 s12, s51, s64
    s_lshl_b32 s16, s50, 1
    s_add_u32 s16, s16, s64
    s_lshl_b32 s17, s50, 1
    s_add_u32 s17, s17, s64
    v_add_u32 v28, 15360, v27
    v_add_u32 v37, 1024, v36
    v_add_u32 v29, 30720, v27
    v_add_u32 v38, 2048, v36
    v_add_u32 v30, 46080, v27
    v_add_u32 v39, 3072, v36
    v_lshl_add_u32 v40, v1, 4, s57
    v_add_u32 v41, 0x10000, v40
    s_bfe_u32 s60, s58, 0x20000
    s_add_u32 m0, s57, 16384
    s_lshl_b32 s61, s60, 20
    s_add_u32 s61, s61, s15
    buffer_load_dwordx4 v19, s[24:27], s61 offen offset:0 lds
    buffer_load_dwordx4 v20, s[24:27], s61 offen offset:1024 lds
    buffer_load_dwordx4 v21, s[24:27], s61 offen offset:2048 lds
    buffer_load_dwordx4 v22, s[24:27], s61 offen offset:3072 lds
    s_waitcnt lgkmcnt(0)
    s_waitcnt vmcnt(4)
    s_barrier
    s_bfe_u32 s60, s58, 0x20002
    s_add_u32 m0, s56, 32768
    s_lshl_b32 s61, s60, 8
    s_add_u32 s61, s61, s4
    buffer_load_dwordx4 v16, s[20:23], s61 offen offset:0 lds
    buffer_load_dwordx4 v17, s[20:23], s61 offen offset:1024 lds
    buffer_load_dwordx4 v18, s[20:23], s61 offen offset:2048 lds
    s_bfe_u32 s60, s58, 0x20002
    s_add_u32 m0, s57, 49152
    s_lshl_b32 s61, s60, 20
    s_add_u32 s61, s61, s14
    buffer_load_dwordx4 v19, s[24:27], s61 offen offset:0 lds
    buffer_load_dwordx4 v20, s[24:27], s61 offen offset:1024 lds
    buffer_load_dwordx4 v21, s[24:27], s61 offen offset:2048 lds
    buffer_load_dwordx4 v22, s[24:27], s61 offen offset:3072 lds
    s_waitcnt vmcnt(7)
    s_barrier
    s_bfe_u32 s60, s58, 0x20002
    s_add_u32 m0, s57, 81920
    s_lshl_b32 s61, s60, 20
    s_add_u32 s61, s61, s15
    buffer_load_dwordx4 v19, s[24:27], s61 offen offset:0 lds
    buffer_load_dwordx4 v20, s[24:27], s61 offen offset:1024 lds
    buffer_load_dwordx4 v21, s[24:27], s61 offen offset:2048 lds
    buffer_load_dwordx4 v22, s[24:27], s61 offen offset:3072 lds
    s_bfe_u32 s60, s58, 0x20004
    s_add_u32 m0, s56, 98304
    s_lshl_b32 s61, s60, 8
    s_add_u32 s61, s61, s4
    buffer_load_dwordx4 v16, s[20:23], s61 offen offset:0 lds
    buffer_load_dwordx4 v17, s[20:23], s61 offen offset:1024 lds
    buffer_load_dwordx4 v18, s[20:23], s61 offen offset:2048 lds
    s_waitcnt vmcnt(7)
    s_barrier
    s_bfe_u32 s60, s58, 0x20004
    s_add_u32 m0, s57, 114688
    s_lshl_b32 s61, s60, 20
    s_add_u32 s61, s61, s14
    buffer_load_dwordx4 v19, s[24:27], s61 offen offset:0 lds
    buffer_load_dwordx4 v20, s[24:27], s61 offen offset:1024 lds
    buffer_load_dwordx4 v21, s[24:27], s61 offen offset:2048 lds
    buffer_load_dwordx4 v22, s[24:27], s61 offen offset:3072 lds
    s_bfe_u32 s60, s58, 0x20004
    s_add_u32 m0, s57, 0
    s_lshl_b32 s61, s60, 20
    s_add_u32 s61, s61, s15
    buffer_load_dwordx4 v19, s[24:27], s61 offen offset:0 lds
    buffer_load_dwordx4 v20, s[24:27], s61 offen offset:1024 lds
    buffer_load_dwordx4 v21, s[24:27], s61 offen offset:2048 lds
    buffer_load_dwordx4 v22, s[24:27], s61 offen offset:3072 lds
    s_waitcnt vmcnt(11)
    s_barrier
    s_bfe_u32 s60, s58, 0x20006
    s_add_u32 m0, s56, 65536
    s_lshl_b32 s61, s60, 8
    s_add_u32 s61, s61, s4
    buffer_load_dwordx4 v16, s[20:23], s61 offen offset:0 lds
    buffer_load_dwordx4 v17, s[20:23], s61 offen offset:1024 lds
    buffer_load_dwordx4 v18, s[20:23], s61 offen offset:2048 lds
    s_bfe_u32 s60, s58, 0x20006
    s_add_u32 m0, s57, 16384
    s_lshl_b32 s61, s60, 20
    s_add_u32 s61, s61, s14
    buffer_load_dwordx4 v19, s[24:27], s61 offen offset:0 lds
    buffer_load_dwordx4 v20, s[24:27], s61 offen offset:1024 lds
    buffer_load_dwordx4 v21, s[24:27], s61 offen offset:2048 lds
    buffer_load_dwordx4 v22, s[24:27], s61 offen offset:3072 lds
    s_waitcnt vmcnt(11)
    s_barrier
    s_bfe_u32 s60, s58, 0x20006
    s_add_u32 m0, s57, 32768
    s_lshl_b32 s61, s60, 20
    s_add_u32 s61, s61, s15
    buffer_load_dwordx4 v19, s[24:27], s61 offen offset:0 lds
    buffer_load_dwordx4 v20, s[24:27], s61 offen offset:1024 lds
    buffer_load_dwordx4 v21, s[24:27], s61 offen offset:2048 lds
    buffer_load_dwordx4 v22, s[24:27], s61 offen offset:3072 lds
    s_waitcnt vmcnt(11)
    s_barrier
    s_bfe_u32 s60, s58, 0x20000
    s_add_u32 m0, s56, 49152
    s_lshl_b32 s61, s60, 8
    s_add_u32 s61, s61, s5
    buffer_load_dwordx4 v16, s[20:23], s61 offen offset:0 lds
    buffer_load_dwordx4 v17, s[20:23], s61 offen offset:1024 lds
    buffer_load_dwordx4 v18, s[20:23], s61 offen offset:2048 lds
    s_waitcnt vmcnt(7)
    s_barrier
    s_bfe_u32 s60, s58, 0x20002
    s_add_u32 m0, s56, 81920
    s_lshl_b32 s61, s60, 8
    s_add_u32 s61, s61, s5
    buffer_load_dwordx4 v16, s[20:23], s61 offen offset:0 lds
    buffer_load_dwordx4 v17, s[20:23], s61 offen offset:1024 lds
    buffer_load_dwordx4 v18, s[20:23], s61 offen offset:2048 lds
    s_bfe_u32 s60, s58, 0x20004
    s_add_u32 m0, s56, 98304
    s_lshl_b32 s61, s60, 8
    s_add_u32 s61, s61, s5
    buffer_load_dwordx4 v16, s[20:23], s61 offen offset:0 lds
    buffer_load_dwordx4 v17, s[20:23], s61 offen offset:1024 lds
    buffer_load_dwordx4 v18, s[20:23], s61 offen offset:2048 lds
    s_waitcnt vmcnt(9)
    s_barrier
    s_bfe_u32 s60, s58, 0x20006
    s_add_u32 m0, s56, 114688
    s_lshl_b32 s61, s60, 8
    s_add_u32 s61, s61, s5
    buffer_load_dwordx4 v16, s[20:23], s61 offen offset:0 lds
    buffer_load_dwordx4 v17, s[20:23], s61 offen offset:1024 lds
    buffer_load_dwordx4 v18, s[20:23], s61 offen offset:2048 lds
    s_add_u32 s60, s51, 0
    s_and_b32 s60, s60, 7
    s_add_u32 m0, s57, 0
    s_lshl_b32 s61, s60, 14
    buffer_load_dwordx4 v23, s[28:31], s61 offen offset:0 lds
    buffer_load_dwordx4 v24, s[28:31], s61 offen offset:1024 lds
    buffer_load_dwordx4 v25, s[28:31], s61 offen offset:2048 lds
    buffer_load_dwordx4 v26, s[28:31], s61 offen offset:3072 lds
    s_waitcnt vmcnt(10)
    s_barrier
    s_add_u32 s60, s51, 1
    s_and_b32 s60, s60, 7
    s_add_u32 m0, s57, 65536
    s_lshl_b32 s61, s60, 14
    buffer_load_dwordx4 v23, s[28:31], s61 offen offset:0 lds
    buffer_load_dwordx4 v24, s[28:31], s61 offen offset:1024 lds
    buffer_load_dwordx4 v25, s[28:31], s61 offen offset:2048 lds
    buffer_load_dwordx4 v26, s[28:31], s61 offen offset:3072 lds
    s_waitcnt vmcnt(8)
    s_barrier
    s_waitcnt vmcnt(0)
    s_barrier
    s_add_u32 s60, s51, 2
    s_and_b32 s60, s60, 7
    s_add_u32 m0, s57, 16384
    s_lshl_b32 s61, s60, 14
    buffer_load_dwordx4 v23, s[28:31], s61 offen offset:0 lds
    buffer_load_dwordx4 v24, s[28:31], s61 offen offset:1024 lds
    buffer_load_dwordx4 v25, s[28:31], s61 offen offset:2048 lds
    buffer_load_dwordx4 v26, s[28:31], s61 offen offset:3072 lds
    s_barrier
    s_add_u32 s60, s51, 3
    s_and_b32 s60, s60, 7
    s_add_u32 m0, s57, 32768
    s_lshl_b32 s61, s60, 14
    buffer_load_dwordx4 v23, s[28:31], s61 offen offset:0 lds
    buffer_load_dwordx4 v24, s[28:31], s61 offen offset:1024 lds
    buffer_load_dwordx4 v25, s[28:31], s61 offen offset:2048 lds
    buffer_load_dwordx4 v26, s[28:31], s61 offen offset:3072 lds
    s_barrier
    s_add_u32 s60, s51, 4
    s_and_b32 s60, s60, 7
    s_add_u32 m0, s57, 49152
    s_lshl_b32 s61, s60, 14
    buffer_load_dwordx4 v23, s[28:31], s61 offen offset:0 lds
    buffer_load_dwordx4 v24, s[28:31], s61 offen offset:1024 lds
    buffer_load_dwordx4 v25, s[28:31], s61 offen offset:2048 lds
    buffer_load_dwordx4 v26, s[28:31], s61 offen offset:3072 lds
    s_add_u32 s60, s51, 5
    s_and_b32 s60, s60, 7
    s_add_u32 m0, s57, 81920
    s_lshl_b32 s61, s60, 14
    buffer_load_dwordx4 v23, s[28:31], s61 offen offset:0 lds
    buffer_load_dwordx4 v24, s[28:31], s61 offen offset:1024 lds
    buffer_load_dwordx4 v25, s[28:31], s61 offen offset:2048 lds
    buffer_load_dwordx4 v26, s[28:31], s61 offen offset:3072 lds
    s_waitcnt vmcnt(8)
    s_barrier
    s_add_u32 s60, s51, 6
    s_and_b32 s60, s60, 7
    s_add_u32 m0, s57, 98304
    s_lshl_b32 s61, s60, 14
    buffer_load_dwordx4 v23, s[28:31], s61 offen offset:0 lds
    buffer_load_dwordx4 v24, s[28:31], s61 offen offset:1024 lds
    buffer_load_dwordx4 v25, s[28:31], s61 offen offset:2048 lds
    buffer_load_dwordx4 v26, s[28:31], s61 offen offset:3072 lds
    s_add_u32 s60, s51, 7
    s_and_b32 s60, s60, 7
    s_add_u32 m0, s57, 114688
    s_lshl_b32 s61, s60, 14
    buffer_load_dwordx4 v23, s[28:31], s61 offen offset:0 lds
    buffer_load_dwordx4 v24, s[28:31], s61 offen offset:1024 lds
    buffer_load_dwordx4 v25, s[28:31], s61 offen offset:2048 lds
    buffer_load_dwordx4 v26, s[28:31], s61 offen offset:3072 lds
    s_waitcnt vmcnt(8)
    s_barrier
    s_add_u32 s60, s12, 0
    s_and_b32 s60, s60, 7
    s_add_u32 m0, s57, 0
    s_lshl_b32 s61, s60, 14
    buffer_load_dwordx4 v36, s[32:35], s61 offen offset:0 lds
    buffer_load_dwordx4 v37, s[32:35], s61 offen offset:1024 lds
    buffer_load_dwordx4 v38, s[32:35], s61 offen offset:2048 lds
    buffer_load_dwordx4 v39, s[32:35], s61 offen offset:3072 lds
    s_add_u32 s60, s12, 0
    s_and_b32 s60, s60, 7
    s_add_u32 m0, s57, 65536
    s_lshl_b32 s61, s60, 14
    s_add_u32 s61, s61, 128
    buffer_load_dwordx4 v36, s[32:35], s61 offen offset:0 lds
    buffer_load_dwordx4 v37, s[32:35], s61 offen offset:1024 lds
    buffer_load_dwordx4 v38, s[32:35], s61 offen offset:2048 lds
    buffer_load_dwordx4 v39, s[32:35], s61 offen offset:3072 lds
    s_waitcnt vmcnt(8)
    s_barrier
    s_add_u32 s60, s12, 2
    s_and_b32 s60, s60, 7
    s_add_u32 m0, s57, 16384
    s_lshl_b32 s61, s60, 14
    buffer_load_dwordx4 v36, s[32:35], s61 offen offset:0 lds
    buffer_load_dwordx4 v37, s[32:35], s61 offen offset:1024 lds
    buffer_load_dwordx4 v38, s[32:35], s61 offen offset:2048 lds
    buffer_load_dwordx4 v39, s[32:35], s61 offen offset:3072 lds
    s_add_u32 s60, s12, 4
    s_and_b32 s60, s60, 7
    s_add_u32 m0, s57, 32768
    s_lshl_b32 s61, s60, 14
    buffer_load_dwordx4 v36, s[32:35], s61 offen offset:0 lds
    buffer_load_dwordx4 v37, s[32:35], s61 offen offset:1024 lds
    buffer_load_dwordx4 v38, s[32:35], s61 offen offset:2048 lds
    buffer_load_dwordx4 v39, s[32:35], s61 offen offset:3072 lds
    s_add_u32 s60, s12, 6
    s_and_b32 s60, s60, 7
    s_add_u32 m0, s57, 49152
    s_lshl_b32 s61, s60, 14
    buffer_load_dwordx4 v36, s[32:35], s61 offen offset:0 lds
    buffer_load_dwordx4 v37, s[32:35], s61 offen offset:1024 lds
    buffer_load_dwordx4 v38, s[32:35], s61 offen offset:2048 lds
    buffer_load_dwordx4 v39, s[32:35], s61 offen offset:3072 lds
    s_waitcnt vmcnt(16)
    s_bitcmp1_b32 10, s50
    s_cbranch_scc1 L_class1
    s_barrier
    s_add_u32 s60, s12, 2
    s_and_b32 s60, s60, 7
    s_add_u32 m0, s57, 81920
    s_lshl_b32 s61, s60, 14
    s_add_u32 s61, s61, 128
    buffer_load_dwordx4 v36, s[32:35], s61 offen offset:0 lds
    buffer_load_dwordx4 v37, s[32:35], s61 offen offset:1024 lds
    buffer_load_dwordx4 v38, s[32:35], s61 offen offset:2048 lds
    buffer_load_dwordx4 v39, s[32:35], s61 offen offset:3072 lds
    s_add_u32 s60, s12, 4
    s_and_b32 s60, s60, 7
    s_add_u32 m0, s57, 98304
    s_lshl_b32 s61, s60, 14
    s_add_u32 s61, s61, 128
    buffer_load_dwordx4 v36, s[32:35], s61 offen offset:0 lds
    buffer_load_dwordx4 v37, s[32:35], s61 offen offset:1024 lds
    buffer_load_dwordx4 v38, s[32:35], s61 offen offset:2048 lds
    buffer_load_dwordx4 v39, s[32:35], s61 offen offset:3072 lds
    s_waitcnt vmcnt(16)
    s_barrier
    s_add_u32 s60, s12, 6
    s_and_b32 s60, s60, 7
    s_add_u32 m0, s57, 114688
    s_lshl_b32 s61, s60, 14
    s_add_u32 s61, s61, 128
    buffer_load_dwordx4 v36, s[32:35], s61 offen offset:0 lds
    buffer_load_dwordx4 v37, s[32:35], s61 offen offset:1024 lds
    buffer_load_dwordx4 v38, s[32:35], s61 offen offset:2048 lds
    buffer_load_dwordx4 v39, s[32:35], s61 offen offset:3072 lds
    s_xor_b32 s60, s16, 0
    s_lshl_b32 s61, s60, 18
    buffer_load_dwordx4 v[44:47], v27, s[36:39], s61 offen offset:0
    buffer_load_dwordx4 v[48:51], v28, s[36:39], s61 offen offset:1024
    buffer_load_dwordx4 v[52:55], v29, s[36:39], s61 offen offset:2048
    buffer_load_dwordx4 v[56:59], v30, s[36:39], s61 offen offset:3072
    s_waitcnt vmcnt(20)
    s_barrier
    s_xor_b32 s60, s17, 0
    s_lshl_b32 s61, s60, 18
    s_add_u32 s61, s61, 131072
    buffer_load_dwordx4 v[60:63], v27, s[36:39], s61 offen offset:0
    buffer_load_dwordx4 v[64:67], v28, s[36:39], s61 offen offset:1024
    buffer_load_dwordx4 v[68:71], v29, s[36:39], s61 offen offset:2048
    buffer_load_dwordx4 v[72:75], v30, s[36:39], s61 offen offset:3072
    s_waitcnt vmcnt(20)
    s_barrier
    s_barrier
    s_waitcnt vmcnt(16)
    s_barrier
    s_xor_b32 s60, s16, 2
    s_add_u32 m0, s57, 16384
    s_lshl_b32 s61, s60, 18
    s_waitcnt vmcnt(5)
    buffer_load_dwordx4 v27, s[36:39], s61 offen offset:0 lds
    s_waitcnt vmcnt(5)
    buffer_load_dwordx4 v28, s[36:39], s61 offen offset:1024 lds
    s_waitcnt vmcnt(5)
    buffer_load_dwordx4 v29, s[36:39], s61 offen offset:2048 lds
    s_waitcnt vmcnt(5)
    buffer_load_dwordx4 v30, s[36:39], s61 offen offset:3072 lds
    s_barrier
    s_xor_b32 s60, s16, 4
    s_add_u32 m0, s57, 32768
    s_lshl_b32 s61, s60, 18
    s_waitcnt vmcnt(5)
    buffer_load_dwordx4 v27, s[36:39], s61 offen offset:0 lds
    s_waitcnt vmcnt(5)
    buffer_load_dwordx4 v28, s[36:39], s61 offen offset:1024 lds
    s_waitcnt vmcnt(5)
    buffer_load_dwordx4 v29, s[36:39], s61 offen offset:2048 lds
    s_waitcnt vmcnt(5)
    buffer_load_dwordx4 v30, s[36:39], s61 offen offset:3072 lds
    s_barrier
    s_xor_b32 s60, s16, 6
    s_add_u32 m0, s57, 49152
    s_lshl_b32 s61, s60, 18
    s_waitcnt vmcnt(5)
    buffer_load_dwordx4 v27, s[36:39], s61 offen offset:0 lds
    s_waitcnt vmcnt(5)
    buffer_load_dwordx4 v28, s[36:39], s61 offen offset:1024 lds
    s_waitcnt vmcnt(5)
    buffer_load_dwordx4 v29, s[36:39], s61 offen offset:2048 lds
    s_waitcnt vmcnt(5)
    buffer_load_dwordx4 v30, s[36:39], s61 offen offset:3072 lds
    s_barrier
    ds_write_b128 v40, v[44:47] offset:0
    ds_write_b128 v40, v[48:51] offset:1024
    ds_write_b128 v40, v[52:55] offset:2048
    ds_write_b128 v40, v[56:59] offset:3072
    s_xor_b32 s60, s17, 2
    s_add_u32 m0, s57, 81920
    s_lshl_b32 s61, s60, 18
    s_add_u32 s61, s61, 131072
    buffer_load_dwordx4 v27, s[36:39], s61 offen offset:0 lds
    buffer_load_dwordx4 v28, s[36:39], s61 offen offset:1024 lds
    buffer_load_dwordx4 v29, s[36:39], s61 offen offset:2048 lds
    buffer_load_dwordx4 v30, s[36:39], s61 offen offset:3072 lds
    ds_write_b128 v41, v[60:63] offset:0
    ds_write_b128 v41, v[64:67] offset:1024
    ds_write_b128 v41, v[68:71] offset:2048
    ds_write_b128 v41, v[72:75] offset:3072
    s_barrier
    s_waitcnt vmcnt(4) lgkmcnt(4)
    s_barrier
    s_xor_b32 s60, s17, 4
    s_add_u32 m0, s57, 98304
    s_lshl_b32 s61, s60, 18
    s_add_u32 s61, s61, 131072
    buffer_load_dwordx4 v27, s[36:39], s61 offen offset:0 lds
    buffer_load_dwordx4 v28, s[36:39], s61 offen offset:1024 lds
    buffer_load_dwordx4 v29, s[36:39], s61 offen offset:2048 lds
    buffer_load_dwordx4 v30, s[36:39], s61 offen offset:3072 lds
    s_xor_b32 s60, s17, 6
    s_add_u32 m0, s57, 114688
    s_lshl_b32 s61, s60, 18
    s_add_u32 s61, s61, 131072
    buffer_load_dwordx4 v27, s[36:39], s61 offen offset:0 lds
    buffer_load_dwordx4 v28, s[36:39], s61 offen offset:1024 lds
    buffer_load_dwordx4 v29, s[36:39], s61 offen offset:2048 lds
    buffer_load_dwordx4 v30, s[36:39], s61 offen offset:3072 lds
    s_waitcnt vmcnt(0) lgkmcnt(0)
    s_barrier
    s_endpgm

L_class1:
    s_barrier
    s_xor_b32 s60, s16, 0
    s_lshl_b32 s61, s60, 18
    buffer_load_dwordx4 v[44:47], v27, s[36:39], s61 offen offset:0
    buffer_load_dwordx4 v[48:51], v28, s[36:39], s61 offen offset:1024
    buffer_load_dwordx4 v[52:55], v29, s[36:39], s61 offen offset:2048
    buffer_load_dwordx4 v[56:59], v30, s[36:39], s61 offen offset:3072
    s_xor_b32 s60, s17, 0
    s_lshl_b32 s61, s60, 18
    s_add_u32 s61, s61, 131072
    buffer_load_dwordx4 v[60:63], v27, s[36:39], s61 offen offset:0
    buffer_load_dwordx4 v[64:67], v28, s[36:39], s61 offen offset:1024
    buffer_load_dwordx4 v[68:71], v29, s[36:39], s61 offen offset:2048
    buffer_load_dwordx4 v[72:75], v30, s[36:39], s61 offen offset:3072
    s_waitcnt vmcnt(16)
    s_barrier
    s_waitcnt vmcnt(12)
    s_barrier
    s_waitcnt vmcnt(8)
    s_barrier
    s_add_u32 s60, s12, 2
    s_and_b32 s60, s60, 7
    s_add_u32 m0, s57, 81920
    s_lshl_b32 s61, s60, 14
    s_add_u32 s61, s61, 128
    buffer_load_dwordx4 v36, s[32:35], s61 offen offset:0 lds
    buffer_load_dwordx4 v37, s[32:35], s61 offen offset:1024 lds
    buffer_load_dwordx4 v38, s[32:35], s61 offen offset:2048 lds
    buffer_load_dwordx4 v39, s[32:35], s61 offen offset:3072 lds
    s_add_u32 s60, s12, 4
    s_and_b32 s60, s60, 7
    s_add_u32 m0, s57, 98304
    s_lshl_b32 s61, s60, 14
    s_add_u32 s61, s61, 128
    buffer_load_dwordx4 v36, s[32:35], s61 offen offset:0 lds
    buffer_load_dwordx4 v37, s[32:35], s61 offen offset:1024 lds
    buffer_load_dwordx4 v38, s[32:35], s61 offen offset:2048 lds
    buffer_load_dwordx4 v39, s[32:35], s61 offen offset:3072 lds
    s_barrier
    s_add_u32 s60, s12, 6
    s_and_b32 s60, s60, 7
    s_add_u32 m0, s57, 114688
    s_lshl_b32 s61, s60, 14
    s_add_u32 s61, s61, 128
    s_waitcnt vmcnt(5)
    buffer_load_dwordx4 v36, s[32:35], s61 offen offset:0 lds
    s_waitcnt vmcnt(5)
    buffer_load_dwordx4 v37, s[32:35], s61 offen offset:1024 lds
    s_waitcnt vmcnt(5)
    buffer_load_dwordx4 v38, s[32:35], s61 offen offset:2048 lds
    s_waitcnt vmcnt(5)
    buffer_load_dwordx4 v39, s[32:35], s61 offen offset:3072 lds
    s_barrier
    s_xor_b32 s60, s16, 2
    s_add_u32 m0, s57, 16384
    s_lshl_b32 s61, s60, 18
    s_waitcnt vmcnt(5)
    buffer_load_dwordx4 v27, s[36:39], s61 offen offset:0 lds
    s_waitcnt vmcnt(5)
    buffer_load_dwordx4 v28, s[36:39], s61 offen offset:1024 lds
    s_waitcnt vmcnt(5)
    buffer_load_dwordx4 v29, s[36:39], s61 offen offset:2048 lds
    s_waitcnt vmcnt(5)
    buffer_load_dwordx4 v30, s[36:39], s61 offen offset:3072 lds
    s_barrier
    s_xor_b32 s60, s16, 4
    s_add_u32 m0, s57, 32768
    s_lshl_b32 s61, s60, 18
    s_waitcnt vmcnt(5)
    buffer_load_dwordx4 v27, s[36:39], s61 offen offset:0 lds
    s_waitcnt vmcnt(5)
    buffer_load_dwordx4 v28, s[36:39], s61 offen offset:1024 lds
    s_waitcnt vmcnt(5)
    buffer_load_dwordx4 v29, s[36:39], s61 offen offset:2048 lds
    s_waitcnt vmcnt(5)
    buffer_load_dwordx4 v30, s[36:39], s61 offen offset:3072 lds
    s_barrier
    s_xor_b32 s60, s16, 6
    s_add_u32 m0, s57, 49152
    s_lshl_b32 s61, s60, 18
    s_waitcnt vmcnt(5)
    buffer_load_dwordx4 v27, s[36:39], s61 offen offset:0 lds
    s_waitcnt vmcnt(5)
    buffer_load_dwordx4 v28, s[36:39], s61 offen offset:1024 lds
    s_waitcnt vmcnt(5)
    buffer_load_dwordx4 v29, s[36:39], s61 offen offset:2048 lds
    s_waitcnt vmcnt(5)
    buffer_load_dwordx4 v30, s[36:39], s61 offen offset:3072 lds
    s_barrier
    ds_write_b128 v40, v[44:47] offset:0
    ds_write_b128 v40, v[48:51] offset:1024
    ds_write_b128 v40, v[52:55] offset:2048
    ds_write_b128 v40, v[56:59] offset:3072
    s_xor_b32 s60, s17, 2
    s_add_u32 m0, s57, 81920
    s_lshl_b32 s61, s60, 18
    s_add_u32 s61, s61, 131072
    buffer_load_dwordx4 v27, s[36:39], s61 offen offset:0 lds
    buffer_load_dwordx4 v28, s[36:39], s61 offen offset:1024 lds
    buffer_load_dwordx4 v29, s[36:39], s61 offen offset:2048 lds
    buffer_load_dwordx4 v30, s[36:39], s61 offen offset:3072 lds
    ds_write_b128 v41, v[60:63] offset:0
    ds_write_b128 v41, v[64:67] offset:1024
    ds_write_b128 v41, v[68:71] offset:2048
    ds_write_b128 v41, v[72:75] offset:3072
    s_barrier
    s_waitcnt vmcnt(4) lgkmcnt(4)
    s_barrier
    s_xor_b32 s60, s17, 4
    s_add_u32 m0, s57, 98304
    s_lshl_b32 s61, s60, 18
    s_add_u32 s61, s61, 131072
    buffer_load_dwordx4 v27, s[36:39], s61 offen offset:0 lds
    buffer_load_dwordx4 v28, s[36:39], s61 offen offset:1024 lds
    buffer_load_dwordx4 v29, s[36:39], s61 offen offset:2048 lds
    buffer_load_dwordx4 v30, s[36:39], s61 offen offset:3072 lds
    s_xor_b32 s60, s17, 6
    s_add_u32 m0, s57, 114688
    s_lshl_b32 s61, s60, 18
    s_add_u32 s61, s61, 131072
    buffer_load_dwordx4 v27, s[36:39], s61 offen offset:0 lds
    buffer_load_dwordx4 v28, s[36:39], s61 offen offset:1024 lds
    buffer_load_dwordx4 v29, s[36:39], s61 offen offset:2048 lds
    buffer_load_dwordx4 v30, s[36:39], s61 offen offset:3072 lds
    s_waitcnt vmcnt(0) lgkmcnt(0)
    s_barrier
    s_endpgm

L_q_slow:
    s_cmp_eq_u32 s65, 0
    s_cbranch_scc1 L_q_ok
    s_sub_u32 s65, s65, 1
    buffer_load_dwordx4 v[64:67], v2, s[40:43], s99 offen offset:0 sc1
    buffer_load_dwordx4 v[68:71], v2, s[40:43], s99 offen offset:1024 sc1
    buffer_load_dwordx4 v[72:75], v2, s[40:43], s99 offen offset:2048 sc1
    buffer_load_dwordx4 v[76:79], v2, s[40:43], s99 offen offset:3072 sc1
    s_waitcnt vmcnt(0)
    v_min3_u32 v8, v67, v71, v75
    v_max3_u32 v15, v67, v71, v75
    v_min_u32 v8, v8, v79
    v_max_u32 v15, v15, v79
    v_cmp_ne_u32 s[68:69], s55, v8
    v_cmp_ne_u32 vcc, s55, v15
    s_nop 1
    s_or_b64 vcc, vcc, s[68:69]
    s_cbranch_scc1 L_q_slow
    s_branch L_q_ok
L_idle:
    v_mov_b32 v8, s55
    v_mov_b32 v9, 0
    v_bfe_u32 v12, v1, 2, 1
    v_lshrrev_b32 v13, 3, v1
    v_lshl_add_u32 v13, v13, 3, v12
    v_lshlrev_b32 v13, 7, v13
    s_lshl_b32 s60, s2, 7
    s_add_u32 s60, s60, 4096
    s_and_b32 s3, s2, 0xc6
    s_lshl_b32 s3, s3, 7
    s_add_u32 s3, s3, 4096
    s_mov_b64 exec, 0
    s_branch L_pg0
L_pgr0:
    s_branch L_pg1
L_pgr1:
    s_barrier
    s_branch L_pg2
L_pgr2:
    s_barrier
    s_mov_b64 exec, 1
    buffer_store_dword v8, v9, s[40:43], s60 offen sc1
    s_mov_b64 exec, -1
    s_barrier
    s_barrier
    s_barrier
    s_barrier
    buffer_load_dword v14, v13, s[40:43], s3 offen sc1
    s_barrier
    s_barrier
    s_barrier
    s_barrier
    s_barrier
L_poll:
    s_waitcnt vmcnt(0)
    v_cmp_ne_u32 vcc, s55, v14
    s_cbranch_vccz L_attn_done
    s_cmp_eq_u32 s65, 0
    s_cbranch_scc1 L_attn_done
    s_sub_u32 s65, s65, 1
    buffer_load_dword v14, v13, s[40:43], s3 offen sc1
    s_branch L_poll
L_o0_slow:
    s_cmp_eq_u32 s65, 0
    s_cbranch_scc1 L_o0_ok
    s_sub_u32 s65, s65, 1
    buffer_load_dwordx4 v[48:51], v5, s[40:43], s12 offen offset:0 sc1
    buffer_load_dwordx4 v[52:55], v5, s[40:43], s12 offen offset:1024 sc1
    buffer_load_dwordx4 v[56:59], v5, s[40:43], s12 offen offset:2048 sc1
    buffer_load_dwordx4 v[60:63], v6, s[40:43], s12 offen offset:0 sc1
    buffer_load_dwordx4 v[64:67], v6, s[40:43], s12 offen offset:1024 sc1
    buffer_load_dwordx4 v[68:71], v6, s[40:43], s12 offen offset:2048 sc1
    buffer_load_dwordx4 v[72:75], v5, s[40:43], s13 offen offset:0 sc1
    buffer_load_dwordx4 v[76:79], v5, s[40:43], s13 offen offset:1024 sc1
    buffer_load_dwordx4 v[80:83], v5, s[40:43], s13 offen offset:2048 sc1
    s_waitcnt vmcnt(0)
    v_cmp_eq_u32 s[68:69], s55, v51
    v_cmp_eq_u32 s[70:71], s55, v55
    v_cmp_eq_u32 vcc, s55, v59
    s_nop 0
    s_or_b64 s[68:69], s[68:69], s[70:71]
    s_or_b64 vcc, vcc, s[68:69]
    s_cbranch_scc1 L_o0_slow
    s_branch L_o0_ok
L_o1_slow:
    s_cmp_eq_u32 s65, 0
    s_cbranch_scc1 L_o1_ok
    s_sub_u32 s65, s65, 1
    buffer_load_dwordx4 v[60:63], v6, s[40:43], s12 offen offset:0 sc1
    buffer_load_dwordx4 v[64:67], v6, s[40:43], s12 offen offset:1024 sc1
    buffer_load_dwordx4 v[68:71], v6, s[40:43], s12 offen offset:2048 sc1
    buffer_load_dwordx4 v[72:75], v5, s[40:43], s13 offen offset:0 sc1
    buffer_load_dwordx4 v[76:79], v5, s[40:43], s13 offen offset:1024 sc1
    buffer_load_dwordx4 v[80:83], v5, s[40:43], s13 offen offset:2048 sc1
    buffer_load_dwordx4 v[84:87], v6, s[40:43], s13 offen offset:0 sc1
    buffer_load_dwordx4 v[88:91], v6, s[40:43], s13 offen offset:1024 sc1
    buffer_load_dwordx4 v[92:95], v6, s[40:43], s13 offen offset:2048 sc1
    s_waitcnt vmcnt(0)
    v_cmp_eq_u32 s[68:69], s55, v63
    v_cmp_eq_u32 s[70:71], s55, v67
    v_cmp_eq_u32 vcc, s55, v71
    s_nop 0
    s_or_b64 s[68:69], s[68:69], s[70:71]
    s_or_b64 vcc, vcc, s[68:69]
    s_cbranch_scc1 L_o1_slow
    s_branch L_o1_ok
L_o2_slow:
    s_cmp_eq_u32 s65, 0
    s_cbranch_scc1 L_o2_ok
    s_sub_u32 s65, s65, 1
    buffer_load_dwordx4 v[72:75], v5, s[40:43], s13 offen offset:0 sc1
    buffer_load_dwordx4 v[76:79], v5, s[40:43], s13 offen offset:1024 sc1
    buffer_load_dwordx4 v[80:83], v5, s[40:43], s13 offen offset:2048 sc1
    buffer_load_dwordx4 v[84:87], v6, s[40:43], s13 offen offset:0 sc1
    buffer_load_dwordx4 v[88:91], v6, s[40:43], s13 offen offset:1024 sc1
    buffer_load_dwordx4 v[92:95], v6, s[40:43], s13 offen offset:2048 sc1
    buffer_load_dwordx4 v[96:99], v5, s[40:43], s14 offen offset:0 sc1
    buffer_load_dwordx4 v[100:103], v5, s[40:43], s14 offen offset:1024 sc1
    buffer_load_dwordx4 v[104:107], v5, s[40:43], s14 offen offset:2048 sc1
    s_waitcnt vmcnt(0)
    v_cmp_eq_u32 s[68:69], s55, v75
    v_cmp_eq_u32 s[70:71], s55, v79
    v_cmp_eq_u32 vcc, s55, v83
    s_nop 0
    s_or_b64 s[68:69], s[68:69], s[70:71]
    s_or_b64 vcc, vcc, s[68:69]
    s_cbranch_scc1 L_o2_slow
    s_branch L_o2_ok
L_o3_slow:
    s_cmp_eq_u32 s65, 0
    s_cbranch_scc1 L_o3_ok
    s_sub_u32 s65, s65, 1
    buffer_load_dwordx4 v[84:87], v6, s[40:43], s13 offen offset:0 sc1
    buffer_load_dwordx4 v[88:91], v6, s[40:43], s13 offen offset:1024 sc1
    buffer_load_dwordx4 v[92:95], v6, s[40:43], s13 offen offset:2048 sc1
    buffer_load_dwordx4 v[96:99], v5, s[40:43], s14 offen offset:0 sc1
    buffer_load_dwordx4 v[100:103], v5, s[40:43], s14 offen offset:1024 sc1
    buffer_load_dwordx4 v[104:107], v5, s[40:43], s14 offen offset:2048 sc1
    buffer_load_dwordx4 v[108:111], v6, s[40:43], s14 offen offset:0 sc1
    buffer_load_dwordx4 v[112:115], v6, s[40:43], s14 offen offset:1024 sc1
    buffer_load_dwordx4 v[116:119], v6, s[40:43], s14 offen offset:2048 sc1
    s_waitcnt vmcnt(0)
    v_cmp_eq_u32 s[68:69], s55, v87
    v_cmp_eq_u32 s[70:71], s55, v91
    v_cmp_eq_u32 vcc, s55, v95
    s_nop 0
    s_or_b64 s[68:69], s[68:69], s[70:71]
    s_or_b64 vcc, vcc, s[68:69]
    s_cbranch_scc1 L_o3_slow
    s_branch L_o3_ok
L_o4_slow:
    s_cmp_eq_u32 s65, 0
    s_cbranch_scc1 L_o4_ok
    s_sub_u32 s65, s65, 1
    buffer_load_dwordx4 v[96:99], v5, s[40:43], s14 offen offset:0 sc1
    buffer_load_dwordx4 v[100:103], v5, s[40:43], s14 offen offset:1024 sc1
    buffer_load_dwordx4 v[104:107], v5, s[40:43], s14 offen offset:2048 sc1
    buffer_load_dwordx4 v[108:111], v6, s[40:43], s14 offen offset:0 sc1
    buffer_load_dwordx4 v[112:115], v6, s[40:43], s14 offen offset:1024 sc1
    buffer_load_dwordx4 v[116:119], v6, s[40:43], s14 offen offset:2048 sc1
    buffer_load_dwordx4 v[120:123], v5, s[40:43], s15 offen offset:0 sc1
    buffer_load_dwordx4 v[124:127], v5, s[40:43], s15 offen offset:1024 sc1
    buffer_load_dwordx4 v[128:131], v5, s[40:43], s15 offen offset:2048 sc1
    s_waitcnt vmcnt(0)
    v_cmp_eq_u32 s[68:69], s55, v99
    v_cmp_eq_u32 s[70:71], s55, v103
    v_cmp_eq_u32 vcc, s55, v107
    s_nop 0
    s_or_b64 s[68:69], s[68:69], s[70:71]
    s_or_b64 vcc, vcc, s[68:69]
    s_cbranch_scc1 L_o4_slow
    s_branch L_o4_ok
L_o5_slow:
    s_cmp_eq_u32 s65, 0
    s_cbranch_scc1 L_o5_ok
    s_sub_u32 s65, s65, 1
    buffer_load_dwordx4 v[108:111], v6, s[40:43], s14 offen offset:0 sc1
    buffer_load_dwordx4 v[112:115], v6, s[40:43], s14 offen offset:1024 sc1
    buffer_load_dwordx4 v[116:119], v6, s[40:43], s14 offen offset:2048 sc1
    buffer_load_dwordx4 v[120:123], v5, s[40:43], s15 offen offset:0 sc1
    buffer_load_dwordx4 v[124:127], v5, s[40:43], s15 offen offset:1024 sc1
    buffer_load_dwordx4 v[128:131], v5, s[40:43], s15 offen offset:2048 sc1
    buffer_load_dwordx4 v[132:135], v6, s[40:43], s15 offen offset:0 sc1
    buffer_load_dwordx4 v[136:139], v6, s[40:43], s15 offen offset:1024 sc1
    buffer_load_dwordx4 v[140:143], v6, s[40:43], s15 offen offset:2048 sc1
    s_waitcnt vmcnt(0)
    v_cmp_eq_u32 s[68:69], s55, v111
    v_cmp_eq_u32 s[70:71], s55, v115
    v_cmp_eq_u32 vcc, s55, v119
    s_nop 0
    s_or_b64 s[68:69], s[68:69], s[70:71]
    s_or_b64 vcc, vcc, s[68:69]
    s_cbranch_scc1 L_o5_slow
    s_branch L_o5_ok
L_o6_slow:
    s_cmp_eq_u32 s65, 0
    s_cbranch_scc1 L_o6_ok
    s_sub_u32 s65, s65, 1
    buffer_load_dwordx4 v[120:123], v5, s[40:43], s15 offen offset:0 sc1
    buffer_load_dwordx4 v[124:127], v5, s[40:43], s15 offen offset:1024 sc1
    buffer_load_dwordx4 v[128:131], v5, s[40:43], s15 offen offset:2048 sc1
    buffer_load_dwordx4 v[132:135], v6, s[40:43], s15 offen offset:0 sc1
    buffer_load_dwordx4 v[136:139], v6, s[40:43], s15 offen offset:1024 sc1
    buffer_load_dwordx4 v[140:143], v6, s[40:43], s15 offen offset:2048 sc1
    buffer_load_dwordx4 v[48:51], v5, s[40:43], s16 offen offset:0 sc1
    buffer_load_dwordx4 v[52:55], v5, s[40:43], s16 offen offset:1024 sc1
    buffer_load_dwordx4 v[56:59], v5, s[40:43], s16 offen offset:2048 sc1
    s_waitcnt vmcnt(0)
    v_cmp_eq_u32 s[68:69], s55, v123
    v_cmp_eq_u32 s[70:71], s55, v127
    v_cmp_eq_u32 vcc, s55, v131
    s_nop 0
    s_or_b64 s[68:69], s[68:69], s[70:71]
    s_or_b64 vcc, vcc, s[68:69]
    s_cbranch_scc1 L_o6_slow
    s_branch L_o6_ok
L_o7_slow:
    s_cmp_eq_u32 s65, 0
    s_cbranch_scc1 L_o7_ok
    s_sub_u32 s65, s65, 1
    buffer_load_dwordx4 v[132:135], v6, s[40:43], s15 offen offset:0 sc1
    buffer_load_dwordx4 v[136:139], v6, s[40:43], s15 offen offset:1024 sc1
    buffer_load_dwordx4 v[140:143], v6, s[40:43], s15 offen offset:2048 sc1
    buffer_load_dwordx4 v[48:51], v5, s[40:43], s16 offen offset:0 sc1
    buffer_load_dwordx4 v[52:55], v5, s[40:43], s16 offen offset:1024 sc1
    buffer_load_dwordx4 v[56:59], v5, s[40:43], s16 offen offset:2048 sc1
    buffer_load_dwordx4 v[60:63], v6, s[40:43], s16 offen offset:0 sc1
    buffer_load_dwordx4 v[64:67], v6, s[40:43], s16 offen offset:1024 sc1
    buffer_load_dwordx4 v[68:71], v6, s[40:43], s16 offen offset:2048 sc1
    s_waitcnt vmcnt(0)
    v_cmp_eq_u32 s[68:69], s55, v135
    v_cmp_eq_u32 s[70:71], s55, v139
    v_cmp_eq_u32 vcc, s55, v143
    s_nop 0
    s_or_b64 s[68:69], s[68:69], s[70:71]
    s_or_b64 vcc, vcc, s[68:69]
    s_cbranch_scc1 L_o7_slow
    s_branch L_o7_ok
L_o8_slow:
    s_cmp_eq_u32 s65, 0
    s_cbranch_scc1 L_o8_ok
    s_sub_u32 s65, s65, 1
    buffer_load_dwordx4 v[48:51], v5, s[40:43], s16 offen offset:0 sc1
    buffer_load_dwordx4 v[52:55], v5, s[40:43], s16 offen offset:1024 sc1
    buffer_load_dwordx4 v[56:59], v5, s[40:43], s16 offen offset:2048 sc1
    buffer_load_dwordx4 v[60:63], v6, s[40:43], s16 offen offset:0 sc1
    buffer_load_dwordx4 v[64:67], v6, s[40:43], s16 offen offset:1024 sc1
    buffer_load_dwordx4 v[68:71], v6, s[40:43], s16 offen offset:2048 sc1
    buffer_load_dwordx4 v[72:75], v5, s[40:43], s17 offen offset:0 sc1
    buffer_load_dwordx4 v[76:79], v5, s[40:43], s17 offen offset:1024 sc1
    buffer_load_dwordx4 v[80:83], v5, s[40:43], s17 offen offset:2048 sc1
    s_waitcnt vmcnt(0)
    v_cmp_eq_u32 s[68:69], s55, v51
    v_cmp_eq_u32 s[70:71], s55, v55
    v_cmp_eq_u32 vcc, s55, v59
    s_nop 0
    s_or_b64 s[68:69], s[68:69], s[70:71]
    s_or_b64 vcc, vcc, s[68:69]
    s_cbranch_scc1 L_o8_slow
    s_branch L_o8_ok
L_o9_slow:
    s_cmp_eq_u32 s65, 0
    s_cbranch_scc1 L_o9_ok
    s_sub_u32 s65, s65, 1
    buffer_load_dwordx4 v[60:63], v6, s[40:43], s16 offen offset:0 sc1
    buffer_load_dwordx4 v[64:67], v6, s[40:43], s16 offen offset:1024 sc1
    buffer_load_dwordx4 v[68:71], v6, s[40:43], s16 offen offset:2048 sc1
    buffer_load_dwordx4 v[72:75], v5, s[40:43], s17 offen offset:0 sc1
    buffer_load_dwordx4 v[76:79], v5, s[40:43], s17 offen offset:1024 sc1
    buffer_load_dwordx4 v[80:83], v5, s[40:43], s17 offen offset:2048 sc1
    buffer_load_dwordx4 v[84:87], v6, s[40:43], s17 offen offset:0 sc1
    buffer_load_dwordx4 v[88:91], v6, s[40:43], s17 offen offset:1024 sc1
    buffer_load_dwordx4 v[92:95], v6, s[40:43], s17 offen offset:2048 sc1
    s_waitcnt vmcnt(0)
    v_cmp_eq_u32 s[68:69], s55, v63
    v_cmp_eq_u32 s[70:71], s55, v67
    v_cmp_eq_u32 vcc, s55, v71
    s_nop 0
    s_or_b64 s[68:69], s[68:69], s[70:71]
    s_or_b64 vcc, vcc, s[68:69]
    s_cbranch_scc1 L_o9_slow
    s_branch L_o9_ok
.p2align 12
L_o10_slow:
    s_cmp_eq_u32 s65, 0
    s_cbranch_scc1 L_o10_ok
    s_sub_u32 s65, s65, 1
    buffer_load_dwordx4 v[72:75], v5, s[40:43], s17 offen offset:0 sc1
    buffer_load_dwordx4 v[76:79], v5, s[40:43], s17 offen offset:1024 sc1
    buffer_load_dwordx4 v[80:83], v5, s[40:43], s17 offen offset:2048 sc1
    buffer_load_dwordx4 v[84:87], v6, s[40:43], s17 offen offset:0 sc1
    buffer_load_dwordx4 v[88:91], v6, s[40:43], s17 offen offset:1024 sc1
    buffer_load_dwordx4 v[92:95], v6, s[40:43], s17 offen offset:2048 sc1
    buffer_load_dwordx4 v[96:99], v5, s[40:43], s18 offen offset:0 sc1
    buffer_load_dwordx4 v[100:103], v5, s[40:43], s18 offen offset:1024 sc1
    buffer_load_dwordx4 v[104:107], v5, s[40:43], s18 offen offset:2048 sc1
    s_waitcnt vmcnt(0)
    v_cmp_eq_u32 s[68:69], s55, v75
    v_cmp_eq_u32 s[70:71], s55, v79
    v_cmp_eq_u32 vcc, s55, v83
    s_nop 0
    s_or_b64 s[68:69], s[68:69], s[70:71]
    s_or_b64 vcc, vcc, s[68:69]
    s_cbranch_scc1 L_o10_slow
    s_branch L_o10_ok
L_o11_slow:
    s_cmp_eq_u32 s65, 0
    s_cbranch_scc1 L_o11_ok
    s_sub_u32 s65, s65, 1
    buffer_load_dwordx4 v[84:87], v6, s[40:43], s17 offen offset:0 sc1
    buffer_load_dwordx4 v[88:91], v6, s[40:43], s17 offen offset:1024 sc1
    buffer_load_dwordx4 v[92:95], v6, s[40:43], s17 offen offset:2048 sc1
    buffer_load_dwordx4 v[96:99], v5, s[40:43], s18 offen offset:0 sc1
    buffer_load_dwordx4 v[100:103], v5, s[40:43], s18 offen offset:1024 sc1
    buffer_load_dwordx4 v[104:107], v5, s[40:43], s18 offen offset:2048 sc1
    buffer_load_dwordx4 v[108:111], v6, s[40:43], s18 offen offset:0 sc1
    buffer_load_dwordx4 v[112:115], v6, s[40:43], s18 offen offset:1024 sc1
    buffer_load_dwordx4 v[116:119], v6, s[40:43], s18 offen offset:2048 sc1
    s_waitcnt vmcnt(0)
    v_cmp_eq_u32 s[68:69], s55, v87
    v_cmp_eq_u32 s[70:71], s55, v91
    v_cmp_eq_u32 vcc, s55, v95
    s_nop 0
    s_or_b64 s[68:69], s[68:69], s[70:71]
    s_or_b64 vcc, vcc, s[68:69]
    s_cbranch_scc1 L_o11_slow
    s_branch L_o11_ok
L_o12_slow:
    s_cmp_eq_u32 s65, 0
    s_cbranch_scc1 L_o12_ok
    s_sub_u32 s65, s65, 1
    buffer_load_dwordx4 v[96:99], v5, s[40:43], s18 offen offset:0 sc1
    buffer_load_dwordx4 v[100:103], v5, s[40:43], s18 offen offset:1024 sc1
    buffer_load_dwordx4 v[104:107], v5, s[40:43], s18 offen offset:2048 sc1
    buffer_load_dwordx4 v[108:111], v6, s[40:43], s18 offen offset:0 sc1
    buffer_load_dwordx4 v[112:115], v6, s[40:43], s18 offen offset:1024 sc1
    buffer_load_dwordx4 v[116:119], v6, s[40:43], s18 offen offset:2048 sc1
    buffer_load_dwordx4 v[120:123], v5, s[40:43], s19 offen offset:0 sc1
    buffer_load_dwordx4 v[124:127], v5, s[40:43], s19 offen offset:1024 sc1
    buffer_load_dwordx4 v[128:131], v5, s[40:43], s19 offen offset:2048 sc1
    s_waitcnt vmcnt(0)
    v_cmp_eq_u32 s[68:69], s55, v99
    v_cmp_eq_u32 s[70:71], s55, v103
    v_cmp_eq_u32 vcc, s55, v107
    s_nop 0
    s_or_b64 s[68:69], s[68:69], s[70:71]
    s_or_b64 vcc, vcc, s[68:69]
    s_cbranch_scc1 L_o12_slow
    s_branch L_o12_ok
L_o13_slow:
    s_cmp_eq_u32 s65, 0
    s_cbranch_scc1 L_o13_ok
    s_sub_u32 s65, s65, 1
    buffer_load_dwordx4 v[108:111], v6, s[40:43], s18 offen offset:0 sc1
    buffer_load_dwordx4 v[112:115], v6, s[40:43], s18 offen offset:1024 sc1
    buffer_load_dwordx4 v[116:119], v6, s[40:43], s18 offen offset:2048 sc1
    buffer_load_dwordx4 v[120:123], v5, s[40:43], s19 offen offset:0 sc1
    buffer_load_dwordx4 v[124:127], v5, s[40:43], s19 offen offset:1024 sc1
    buffer_load_dwordx4 v[128:131], v5, s[40:43], s19 offen offset:2048 sc1
    buffer_load_dwordx4 v[132:135], v6, s[40:43], s19 offen offset:0 sc1
    buffer_load_dwordx4 v[136:139], v6, s[40:43], s19 offen offset:1024 sc1
    buffer_load_dwordx4 v[140:143], v6, s[40:43], s19 offen offset:2048 sc1
    s_waitcnt vmcnt(0)
    v_cmp_eq_u32 s[68:69], s55, v111
    v_cmp_eq_u32 s[70:71], s55, v115
    v_cmp_eq_u32 vcc, s55, v119
    s_nop 0
    s_or_b64 s[68:69], s[68:69], s[70:71]
    s_or_b64 vcc, vcc, s[68:69]
    s_cbranch_scc1 L_o13_slow
    s_branch L_o13_ok
L_o14_slow:
    s_cmp_eq_u32 s65, 0
    s_cbranch_scc1 L_o14_ok
    s_sub_u32 s65, s65, 1
    buffer_load_dwordx4 v[120:123], v5, s[40:43], s19 offen offset:0 sc1
    buffer_load_dwordx4 v[124:127], v5, s[40:43], s19 offen offset:1024 sc1
    buffer_load_dwordx4 v[128:131], v5, s[40:43], s19 offen offset:2048 sc1
    buffer_load_dwordx4 v[132:135], v6, s[40:43], s19 offen offset:0 sc1
    buffer_load_dwordx4 v[136:139], v6, s[40:43], s19 offen offset:1024 sc1
    buffer_load_dwordx4 v[140:143], v6, s[40:43], s19 offen offset:2048 sc1
    s_waitcnt vmcnt(0)
    v_cmp_eq_u32 s[68:69], s55, v123
    v_cmp_eq_u32 s[70:71], s55, v127
    v_cmp_eq_u32 vcc, s55, v131
    s_nop 0
    s_or_b64 s[68:69], s[68:69], s[70:71]
    s_or_b64 vcc, vcc, s[68:69]
    s_cbranch_scc1 L_o14_slow
    s_branch L_o14_ok
L_o15_slow:
    s_cmp_eq_u32 s65, 0
    s_cbranch_scc1 L_o15_ok
    s_sub_u32 s65, s65, 1
    buffer_load_dwordx4 v[132:135], v6, s[40:43], s19 offen offset:0 sc1
    buffer_load_dwordx4 v[136:139], v6, s[40:43], s19 offen offset:1024 sc1
    buffer_load_dwordx4 v[140:143], v6, s[40:43], s19 offen offset:2048 sc1
    s_waitcnt vmcnt(0)
    v_cmp_eq_u32 s[68:69], s55, v135
    v_cmp_eq_u32 s[70:71], s55, v139
    v_cmp_eq_u32 vcc, s55, v143
    s_nop 0
    s_or_b64 s[68:69], s[68:69], s[70:71]
    s_or_b64 vcc, vcc, s[68:69]
    s_cbranch_scc1 L_o15_slow
    s_branch L_o15_ok
.p2align 6
L_compute:
    s_getpc_b64 s[10:11]
L_pc:
    s_sub_u32 s10, s10, L_pc-standalone__gqa_block_cached__near_ridge_kernel
    s_subb_u32 s11, s11, 0
    s_bfe_u32 s63, s2, 0x30003
    s_lshl_b32 s63, s63, 5
    v_bfe_u32 v8, v0, 3, 5
    v_add_u32 v8, s63, v8
    v_lshlrev_b32 v8, 7, v8
    v_min_u32 v8, L_last-standalone__gqa_block_cached__near_ridge_kernel, v8
    v_mov_b32 v9, s11
    v_add_co_u32 v8, vcc, s10, v8
    v_lshlrev_b32 v2, 4, v1
    v_bfe_u32 v10, v1, 2, 2
    v_addc_co_u32 v9, vcc, 0, v9, vcc
    global_load_dword v15, v[8:9], off
    s_load_dwordx2 s[44:45], s[0:1], 40
    s_lshl_b32 s63, s50, 7
    s_waitcnt lgkmcnt(0)
    s_load_dword s55, s[40:41], s63
    s_mov_b32 s42, 268435456
    s_mov_b32 s43, 0x20000
    s_mov_b32 s46, 786432
    s_mov_b32 s47, 0x20000
    v_and_b32 v11, 3, v1
    v_lshlrev_b32 v11, 3, v11
    v_and_b32 v8, 1, v4
    v_lshl_or_b32 v8, v8, 2, v10
    s_lshl_b32 s63, s52, 1
    v_xor_b32 v8, s63, v8
    v_lshl_add_u32 v8, v8, 5, v11
    v_lshl_add_u32 v9, v4, 3, v10
    v_lshl_add_u32 v36, v9, 8, v8
    v_xor_b32 v37, 32, v36
    v_add_u32 v38, 0x10000, v36
    v_add_u32 v39, 0x10000, v37
    v_xor_b32 v8, v7, v4
    v_lshlrev_b32 v8, 4, v8
    v_lshl_add_u32 v104, v7, 8, v8
    s_lshr_b32 s63, 0, s50
    s_and_b32 s63, s63, 1
    s_lshl_b32 s63, s63, 7
    v_xor_b32 v104, s63, v104
    v_xor_b32 v105, 64, v104
    v_xor_b32 v106, 128, v104
    v_xor_b32 v107, 192, v104
    v_add_u32 v108, 0x10000, v104
    v_add_u32 v109, 0x10000, v105
    v_add_u32 v110, 0x10000, v106
    v_add_u32 v111, 0x10000, v107
    v_lshl_add_u32 v8, v4, 2, v10
    v_bfe_u32 v12, v8, 1, 2
    v_lshl_add_u32 v12, v12, 5, v11
    v_lshl_add_u32 v24, v8, 7, v12
    v_xor_b32 v25, 32, v24
    v_xor_b32 v26, 64, v24
    v_xor_b32 v27, 96, v24
    v_add_u32 v28, 0x10000, v24
    v_add_u32 v29, 0x10000, v25
    v_add_u32 v30, 0x10000, v26
    v_add_u32 v31, 0x10000, v27
    v_and_b32 v8, 1, v4
    v_lshrrev_b32 v9, 1, v4
    v_lshl_add_u32 v8, v8, 1, v9
    v_xor_b32 v8, v8, v7
    v_lshlrev_b32 v8, 4, v8
    v_lshl_add_u32 v16, v7, 8, v8
    v_xor_b32 v17, 64, v16
    v_xor_b32 v18, 128, v16
    v_xor_b32 v19, 192, v16
    v_add_u32 v20, 0x10000, v16
    v_add_u32 v21, 0x10000, v17
    v_add_u32 v22, 0x10000, v18
    v_add_u32 v23, 0x10000, v19
    s_add_u32 s63, s56, 131072
    v_add_u32 v34, s63, v2
    s_lshl_b32 s61, s52, 10
    s_add_u32 s63, s61, 131072
    v_add_u32 v35, s63, v2
    v_add_u32 v3, 4096, v2
    v_mov_b32 v8, 0x3f803f80
    s_mov_b32 s66, 0x3e0293ee
    s_mov_b32 s67, 0x3e0293ee
    s_mov_b32 s8, 0x3f80
    s_mov_b32 s9, 0x3f800000
    v_accvgpr_write_b32 a48, v8
    v_accvgpr_write_b32 a49, v8
    v_accvgpr_write_b32 a50, v8
    v_accvgpr_write_b32 a51, v8
    s_lshl_b32 s99, s2, 14
    s_add_u32 s99, s99, 8388608
    s_xor_b32 s10, s99, 16384
    s_add_u32 s10, s10, s61
    s_add_u32 s28, s10, 8192
    s_add_u32 s99, s99, s57
    s_and_b32 s64, s52, 1
    s_lshl_b32 s58, s64, 2
    s_lshr_b32 s63, s52, 1
    s_xor_b32 s63, s63, 1
    s_and_b32 s60, s2, 0xc6
    s_or_b32 s63, s63, s60
    s_lshl_b32 s63, s63, 14
    s_add_u32 s63, s63, 8388608
    s_and_b32 s59, s51, 7
    s_and_b32 s60, s59, 1
    s_lshl_b32 s60, s60, 12
    v_add_u32 v5, s60, v2
    s_lshl_b32 s60, s48, 4
    v_xor_b32 v5, s60, v5
    v_xor_b32 v6, 4096, v5
    s_lshr_b32 s60, s59, 1
    s_xor_b32 s58, s58, s60
    s_lshl_b32 s62, s50, 1
    s_xor_b32 s62, s62, s58
    s_xor_b32 s60, s62, 0
    s_lshl_b32 s60, s60, 17
    s_add_u32 s12, s60, s63
    s_xor_b32 s60, s62, 1
    s_lshl_b32 s60, s60, 17
    s_add_u32 s13, s60, s63
    s_xor_b32 s60, s62, 2
    s_lshl_b32 s60, s60, 17
    s_add_u32 s14, s60, s63
    s_xor_b32 s60, s62, 3
    s_lshl_b32 s60, s60, 17
    s_add_u32 s15, s60, s63
    s_add_u32 s63, s63, 8192
    s_lshl_b32 s62, s50, 1
    s_xor_b32 s62, s62, s58
    s_xor_b32 s60, s62, 0
    s_lshl_b32 s60, s60, 17
    s_add_u32 s16, s60, s63
    s_xor_b32 s60, s62, 1
    s_lshl_b32 s60, s60, 17
    s_add_u32 s17, s60, s63
    s_xor_b32 s60, s62, 2
    s_lshl_b32 s60, s60, 17
    s_add_u32 s18, s60, s63
    s_xor_b32 s60, s62, 3
    s_lshl_b32 s60, s60, 17
    s_add_u32 s19, s60, s63
    s_lshr_b32 s4, s52, 1
    s_lshl_b32 s5, s50, 1
    s_add_u32 s4, s4, s5
    s_mul_i32 s4, s4, 48
    s_add_u32 s4, s4, s48
    s_lshl_b32 s4, s4, 11
    s_lshl_b32 s5, s49, 3
    s_add_u32 s5, s5, s51
    s_lshl_b32 s5, s5, 1
    s_and_b32 s60, s52, 1
    s_add_u32 s5, s5, s60
    s_lshl_b32 s5, s5, 6
    s_add_u32 s4, s4, s5
    s_lshl_b32 s60, s53, 3
    s_add_u32 s60, s60, s51
    s_lshl_b32 s60, s60, 16
    s_add_u32 s60, s60, 4194304
    s_lshl_b32 s5, s48, 12
    s_add_u32 s60, s60, s5
    s_lshl_b32 s6, s52, 14
    s_add_u32 s6, s6, s60
    s_lshl_b32 s5, s48, 14
    s_add_u32 s60, s60, s5
    s_lshl_b32 s5, s52, 10
    s_add_u32 s60, s60, s5
    s_xor_b32 s96, s60, 4096
    s_xor_b32 s97, s60, 8192
    s_xor_b32 s98, s60, 12288
    s_mov_b32 s65, 262144
    s_xor_b32 s32, s60, 16384
    s_xor_b32 s33, s60, 32768
    s_xor_b32 s34, s60, 49152
    s_waitcnt lgkmcnt(0)
    s_mul_i32 s11, s55, 0x19660d
    s_add_u32 s11, s11, 0x3c6ef35f
    s_and_b32 s55, s11, 0xffff
    s_or_b32 s55, s55, 0x7fa50000
    v_mov_b32 v67, s55
    v_mov_b32 v71, s55
    v_mov_b32 v75, s55
    v_mov_b32 v79, s55
    s_barrier
    ds_read_b64_tr_b16 v[112:113], v38 offset:0
    ds_read_b64_tr_b16 v[114:115], v38 offset:1024
    ds_read_b128 v[80:83], v104 offset:0
    ds_read_b64_tr_b16 v[116:117], v39 offset:0
    ds_read_b64_tr_b16 v[118:119], v39 offset:1024
    ds_read_b128 v[84:87], v104 offset:4096
    ds_read_b128 v[88:91], v104 offset:8192
    ds_read_b64_tr_b16 v[120:121], v38 offset:8192
    ds_read_b64_tr_b16 v[122:123], v38 offset:9216
    ds_read_b128 v[92:95], v105 offset:0
    ds_read_b64_tr_b16 v[124:125], v39 offset:8192
    ds_read_b64_tr_b16 v[126:127], v39 offset:9216
    ds_read_b128 v[96:99], v105 offset:4096
    ds_read_b128 v[100:103], v105 offset:8192
    s_waitcnt lgkmcnt(11)
    v_mfma_f32_16x16x32_bf16 v[40:43], v[112:115], v[80:83], 0
    s_waitcnt lgkmcnt(9)
    v_mfma_f32_16x16x32_bf16 v[52:55], v[116:119], v[80:83], 0
    s_waitcnt lgkmcnt(8)
    v_mfma_f32_16x16x32_bf16 v[44:47], v[112:115], v[84:87], 0
    v_mfma_f32_16x16x32_bf16 v[56:59], v[116:119], v[84:87], 0
    s_waitcnt lgkmcnt(7)
    v_mfma_f32_16x16x32_bf16 v[48:51], v[112:115], v[88:91], 0
    v_mfma_f32_16x16x32_bf16 v[60:63], v[116:119], v[88:91], 0
    s_waitcnt lgkmcnt(0)
    s_barrier
    ds_read_b64_tr_b16 v[128:129], v36 offset:16384
    ds_read_b64_tr_b16 v[130:131], v36 offset:17408
    ds_read_b128 v[80:83], v106 offset:0
    v_mfma_f32_16x16x32_bf16 v[40:43], v[120:123], v[92:95], v[40:43]
    ds_read_b64_tr_b16 v[132:133], v37 offset:16384
    ds_read_b64_tr_b16 v[134:135], v37 offset:17408
    v_mfma_f32_16x16x32_bf16 v[52:55], v[124:127], v[92:95], v[52:55]
    ds_read_b128 v[84:87], v106 offset:4096
    ds_read_b128 v[88:91], v106 offset:8192
    v_mfma_f32_16x16x32_bf16 v[44:47], v[120:123], v[96:99], v[44:47]
    ds_read_b64_tr_b16 v[136:137], v36 offset:24576
    v_mfma_f32_16x16x32_bf16 v[56:59], v[124:127], v[96:99], v[56:59]
    ds_read_b64_tr_b16 v[138:139], v36 offset:25600
    ds_read_b64_tr_b16 v[140:141], v37 offset:24576
    v_mfma_f32_16x16x32_bf16 v[48:51], v[120:123], v[100:103], v[48:51]
    ds_read_b64_tr_b16 v[142:143], v37 offset:25600
    v_mfma_f32_16x16x32_bf16 v[60:63], v[124:127], v[100:103], v[60:63]
    s_waitcnt lgkmcnt(8)
    ds_read_b128 v[92:95], v107 offset:0
    v_mfma_f32_16x16x32_bf16 v[40:43], v[128:131], v[80:83], v[40:43]
    s_waitcnt lgkmcnt(7)
    ds_read_b128 v[96:99], v107 offset:4096
    v_mfma_f32_16x16x32_bf16 v[52:55], v[132:135], v[80:83], v[52:55]
    s_waitcnt lgkmcnt(7)
    ds_read_b128 v[100:103], v107 offset:8192
    v_mfma_f32_16x16x32_bf16 v[44:47], v[128:131], v[84:87], v[44:47]
    v_mfma_f32_16x16x32_bf16 v[56:59], v[132:135], v[84:87], v[56:59]
    s_waitcnt lgkmcnt(7)
    v_mfma_f32_16x16x32_bf16 v[48:51], v[128:131], v[88:91], v[48:51]
    v_mfma_f32_16x16x32_bf16 v[60:63], v[132:135], v[88:91], v[60:63]
    s_waitcnt lgkmcnt(0)
    s_barrier
    ds_read_b64_tr_b16 v[144:145], v36 offset:49152
    ds_read_b64_tr_b16 v[146:147], v36 offset:50176
    ds_read_b128 v[80:83], v104 offset:32768
    v_mfma_f32_16x16x32_bf16 v[40:43], v[136:139], v[92:95], v[40:43]
    ds_read_b64_tr_b16 v[148:149], v37 offset:49152
    ds_read_b64_tr_b16 v[150:151], v37 offset:50176
    v_mfma_f32_16x16x32_bf16 v[52:55], v[140:143], v[92:95], v[52:55]
    ds_read_b128 v[84:87], v104 offset:36864
    ds_read_b128 v[88:91], v104 offset:40960
    v_mfma_f32_16x16x32_bf16 v[44:47], v[136:139], v[96:99], v[44:47]
    ds_read_b64_tr_b16 v[152:153], v36 offset:57344
    v_mfma_f32_16x16x32_bf16 v[56:59], v[140:143], v[96:99], v[56:59]
    ds_read_b64_tr_b16 v[154:155], v36 offset:58368
    ds_read_b64_tr_b16 v[156:157], v37 offset:57344
    v_mfma_f32_16x16x32_bf16 v[48:51], v[136:139], v[100:103], v[48:51]
    ds_read_b64_tr_b16 v[158:159], v37 offset:58368
    v_mfma_f32_16x16x32_bf16 v[60:63], v[140:143], v[100:103], v[60:63]
    s_waitcnt lgkmcnt(8)
    ds_read_b128 v[92:95], v105 offset:32768
    v_mfma_f32_16x16x32_bf16 v[40:43], v[144:147], v[80:83], v[40:43]
    s_waitcnt lgkmcnt(7)
    ds_read_b128 v[96:99], v105 offset:36864
    v_mfma_f32_16x16x32_bf16 v[52:55], v[148:151], v[80:83], v[52:55]
    s_waitcnt lgkmcnt(7)
    ds_read_b128 v[100:103], v105 offset:40960
    v_mfma_f32_16x16x32_bf16 v[44:47], v[144:147], v[84:87], v[44:47]
    v_mfma_f32_16x16x32_bf16 v[56:59], v[148:151], v[84:87], v[56:59]
    s_waitcnt lgkmcnt(7)
    v_mfma_f32_16x16x32_bf16 v[48:51], v[144:147], v[88:91], v[48:51]
    v_mfma_f32_16x16x32_bf16 v[60:63], v[148:151], v[88:91], v[60:63]
    s_waitcnt lgkmcnt(0)
    s_barrier
    ds_read_b64_tr_b16 v[160:161], v38 offset:16384
    ds_read_b64_tr_b16 v[162:163], v38 offset:17408
    ds_read_b128 v[80:83], v106 offset:32768
    v_mfma_f32_16x16x32_bf16 v[40:43], v[152:155], v[92:95], v[40:43]
    ds_read_b64_tr_b16 v[164:165], v39 offset:16384
    ds_read_b64_tr_b16 v[166:167], v39 offset:17408
    v_mfma_f32_16x16x32_bf16 v[52:55], v[156:159], v[92:95], v[52:55]
    ds_read_b128 v[84:87], v106 offset:36864
    ds_read_b128 v[88:91], v106 offset:40960
    v_mfma_f32_16x16x32_bf16 v[44:47], v[152:155], v[96:99], v[44:47]
    ds_read_b64_tr_b16 v[168:169], v38 offset:24576
    v_mfma_f32_16x16x32_bf16 v[56:59], v[156:159], v[96:99], v[56:59]
    ds_read_b64_tr_b16 v[170:171], v38 offset:25600
    ds_read_b64_tr_b16 v[172:173], v39 offset:24576
    v_mfma_f32_16x16x32_bf16 v[48:51], v[152:155], v[100:103], v[48:51]
    ds_read_b64_tr_b16 v[174:175], v39 offset:25600
    v_mfma_f32_16x16x32_bf16 v[60:63], v[156:159], v[100:103], v[60:63]
    s_waitcnt lgkmcnt(8)
    ds_read_b128 v[92:95], v107 offset:32768
    v_mfma_f32_16x16x32_bf16 v[40:43], v[160:163], v[80:83], v[40:43]
    s_waitcnt lgkmcnt(7)
    ds_read_b128 v[96:99], v107 offset:36864
    v_mfma_f32_16x16x32_bf16 v[52:55], v[164:167], v[80:83], v[52:55]
    s_waitcnt lgkmcnt(7)
    ds_read_b128 v[100:103], v107 offset:40960
    v_mfma_f32_16x16x32_bf16 v[44:47], v[160:163], v[84:87], v[44:47]
    v_mfma_f32_16x16x32_bf16 v[56:59], v[164:167], v[84:87], v[56:59]
    s_waitcnt lgkmcnt(7)
    v_mfma_f32_16x16x32_bf16 v[48:51], v[160:163], v[88:91], v[48:51]
    v_mfma_f32_16x16x32_bf16 v[60:63], v[164:167], v[88:91], v[60:63]
    s_waitcnt lgkmcnt(0)
    s_barrier
    ds_read_b64_tr_b16 v[176:177], v38 offset:49152
    ds_read_b64_tr_b16 v[178:179], v38 offset:50176
    ds_read_b128 v[80:83], v108 offset:32768
    v_mfma_f32_16x16x32_bf16 v[40:43], v[168:171], v[92:95], v[40:43]
    ds_read_b64_tr_b16 v[180:181], v39 offset:49152
    ds_read_b64_tr_b16 v[182:183], v39 offset:50176
    v_mfma_f32_16x16x32_bf16 v[52:55], v[172:175], v[92:95], v[52:55]
    ds_read_b128 v[84:87], v108 offset:36864
    ds_read_b128 v[88:91], v108 offset:40960
    v_mfma_f32_16x16x32_bf16 v[44:47], v[168:171], v[96:99], v[44:47]
    ds_read_b64_tr_b16 v[184:185], v38 offset:57344
    v_mfma_f32_16x16x32_bf16 v[56:59], v[172:175], v[96:99], v[56:59]
    ds_read_b64_tr_b16 v[186:187], v38 offset:58368
    ds_read_b64_tr_b16 v[188:189], v39 offset:57344
    v_mfma_f32_16x16x32_bf16 v[48:51], v[168:171], v[100:103], v[48:51]
    ds_read_b64_tr_b16 v[190:191], v39 offset:58368
    v_mfma_f32_16x16x32_bf16 v[60:63], v[172:175], v[100:103], v[60:63]
    s_waitcnt lgkmcnt(8)
    ds_read_b128 v[92:95], v109 offset:32768
    v_mfma_f32_16x16x32_bf16 v[40:43], v[176:179], v[80:83], v[40:43]
    s_waitcnt lgkmcnt(7)
    ds_read_b128 v[96:99], v109 offset:36864
    v_mfma_f32_16x16x32_bf16 v[52:55], v[180:183], v[80:83], v[52:55]
    s_waitcnt lgkmcnt(7)
    ds_read_b128 v[100:103], v109 offset:40960
    v_mfma_f32_16x16x32_bf16 v[44:47], v[176:179], v[84:87], v[44:47]
    v_mfma_f32_16x16x32_bf16 v[56:59], v[180:183], v[84:87], v[56:59]
    s_waitcnt lgkmcnt(7)
    v_mfma_f32_16x16x32_bf16 v[48:51], v[176:179], v[88:91], v[48:51]
    v_mfma_f32_16x16x32_bf16 v[60:63], v[180:183], v[88:91], v[60:63]
    s_waitcnt lgkmcnt(0)
    s_barrier
    ds_read_b64_tr_b16 v[192:193], v36 offset:0
    ds_read_b64_tr_b16 v[194:195], v36 offset:1024
    ds_read_b128 v[80:83], v110 offset:32768
    v_mfma_f32_16x16x32_bf16 v[40:43], v[184:187], v[92:95], v[40:43]
    ds_read_b64_tr_b16 v[196:197], v37 offset:0
    ds_read_b64_tr_b16 v[198:199], v37 offset:1024
    v_mfma_f32_16x16x32_bf16 v[52:55], v[188:191], v[92:95], v[52:55]
    ds_read_b128 v[84:87], v110 offset:36864
    ds_read_b128 v[88:91], v110 offset:40960
    v_mfma_f32_16x16x32_bf16 v[44:47], v[184:187], v[96:99], v[44:47]
    ds_read_b64_tr_b16 a[0:1], v36 offset:8192
    v_mfma_f32_16x16x32_bf16 v[56:59], v[188:191], v[96:99], v[56:59]
    ds_read_b64_tr_b16 a[2:3], v36 offset:9216
    ds_read_b64_tr_b16 a[4:5], v37 offset:8192
    v_mfma_f32_16x16x32_bf16 v[48:51], v[184:187], v[100:103], v[48:51]
    ds_read_b64_tr_b16 a[6:7], v37 offset:9216
    v_mfma_f32_16x16x32_bf16 v[60:63], v[188:191], v[100:103], v[60:63]
    s_waitcnt lgkmcnt(8)
    ds_read_b128 v[92:95], v111 offset:32768
    v_mfma_f32_16x16x32_bf16 v[40:43], v[192:195], v[80:83], v[40:43]
    s_waitcnt lgkmcnt(7)
    ds_read_b128 v[96:99], v111 offset:36864
    v_mfma_f32_16x16x32_bf16 v[52:55], v[196:199], v[80:83], v[52:55]
    s_waitcnt lgkmcnt(7)
    ds_read_b128 v[100:103], v111 offset:40960
    v_mfma_f32_16x16x32_bf16 v[44:47], v[192:195], v[84:87], v[44:47]
    v_mfma_f32_16x16x32_bf16 v[56:59], v[196:199], v[84:87], v[56:59]
    s_waitcnt lgkmcnt(7)
    v_mfma_f32_16x16x32_bf16 v[48:51], v[192:195], v[88:91], v[48:51]
    v_mfma_f32_16x16x32_bf16 v[60:63], v[196:199], v[88:91], v[60:63]
    s_waitcnt lgkmcnt(0)
    s_barrier
    ds_read_b64_tr_b16 a[8:9], v36 offset:16384
    ds_read_b64_tr_b16 a[10:11], v36 offset:17408
    ds_read_b128 v[80:83], v108 offset:0
    v_mfma_f32_16x16x32_bf16 v[40:43], a[0:3], v[92:95], v[40:43]
    ds_read_b64_tr_b16 a[12:13], v37 offset:16384
    ds_read_b64_tr_b16 a[14:15], v37 offset:17408
    v_mfma_f32_16x16x32_bf16 v[52:55], a[4:7], v[92:95], v[52:55]
    ds_read_b128 v[84:87], v108 offset:4096
    ds_read_b128 v[88:91], v108 offset:8192
    v_mfma_f32_16x16x32_bf16 v[44:47], a[0:3], v[96:99], v[44:47]
    ds_read_b64_tr_b16 a[16:17], v36 offset:24576
    v_mfma_f32_16x16x32_bf16 v[56:59], a[4:7], v[96:99], v[56:59]
    ds_read_b64_tr_b16 a[18:19], v36 offset:25600
    ds_read_b64_tr_b16 a[20:21], v37 offset:24576
    v_mfma_f32_16x16x32_bf16 v[48:51], a[0:3], v[100:103], v[48:51]
    ds_read_b64_tr_b16 a[22:23], v37 offset:25600
    v_mfma_f32_16x16x32_bf16 v[60:63], a[4:7], v[100:103], v[60:63]
    s_waitcnt lgkmcnt(8)
    ds_read_b128 v[92:95], v109 offset:0
    v_mfma_f32_16x16x32_bf16 v[40:43], a[8:11], v[80:83], v[40:43]
    s_waitcnt lgkmcnt(7)
    ds_read_b128 v[96:99], v109 offset:4096
    v_mfma_f32_16x16x32_bf16 v[52:55], a[12:15], v[80:83], v[52:55]
    s_waitcnt lgkmcnt(7)
    ds_read_b128 v[100:103], v109 offset:8192
    v_mfma_f32_16x16x32_bf16 v[44:47], a[8:11], v[84:87], v[44:47]
    v_mfma_f32_16x16x32_bf16 v[56:59], a[12:15], v[84:87], v[56:59]
    s_waitcnt lgkmcnt(7)
    v_mfma_f32_16x16x32_bf16 v[48:51], a[8:11], v[88:91], v[48:51]
    v_mfma_f32_16x16x32_bf16 v[60:63], a[12:15], v[88:91], v[60:63]
    s_waitcnt lgkmcnt(2)
    v_mfma_f32_16x16x32_bf16 v[40:43], a[16:19], v[92:95], v[40:43]
    ds_read_b128 v[80:83], v110 offset:0
    v_mfma_f32_16x16x32_bf16 v[52:55], a[20:23], v[92:95], v[52:55]
    s_waitcnt lgkmcnt(2)
    ds_read_b128 v[84:87], v110 offset:4096
    v_mfma_f32_16x16x32_bf16 v[44:47], a[16:19], v[96:99], v[44:47]
    ds_read_b128 v[88:91], v110 offset:8192
    v_mfma_f32_16x16x32_bf16 v[56:59], a[20:23], v[96:99], v[56:59]
    s_waitcnt lgkmcnt(3)
    v_mfma_f32_16x16x32_bf16 v[48:51], a[16:19], v[100:103], v[48:51]
    v_mfma_f32_16x16x32_bf16 v[60:63], a[20:23], v[100:103], v[60:63]
    ds_read_b128 v[92:95], v111 offset:0
    ds_read_b128 v[96:99], v111 offset:4096
    ds_read_b128 v[100:103], v111 offset:8192
    s_waitcnt lgkmcnt(0)
    s_barrier
    ds_read_b64_tr_b16 a[24:25], v36 offset:32768
    ds_read_b64_tr_b16 a[26:27], v36 offset:33792
    ds_read_b64_tr_b16 a[32:33], v36 offset:40960
    ds_read_b64_tr_b16 a[34:35], v36 offset:41984
    ds_read_b64_tr_b16 a[28:29], v37 offset:32768
    ds_read_b64_tr_b16 a[30:31], v37 offset:33792
    ds_read_b64_tr_b16 a[36:37], v37 offset:40960
    ds_read_b64_tr_b16 a[38:39], v37 offset:41984
    s_waitcnt lgkmcnt(6)
    v_mfma_f32_16x16x32_bf16 v[40:43], a[24:27], v[80:83], v[40:43]
    v_mfma_f32_16x16x32_bf16 v[44:47], a[24:27], v[84:87], v[44:47]
    v_mfma_f32_16x16x32_bf16 v[48:51], a[24:27], v[88:91], v[48:51]
    s_waitcnt lgkmcnt(4)
    v_mfma_f32_16x16x32_bf16 v[40:43], a[32:35], v[92:95], v[40:43]
    v_mfma_f32_16x16x32_bf16 v[44:47], a[32:35], v[96:99], v[44:47]
    v_mfma_f32_16x16x32_bf16 v[48:51], a[32:35], v[100:103], v[48:51]
    s_waitcnt lgkmcnt(2)
    v_mfma_f32_16x16x32_bf16 v[52:55], a[28:31], v[80:83], v[52:55]
    v_mfma_f32_16x16x32_bf16 v[56:59], a[28:31], v[84:87], v[56:59]
    v_mfma_f32_16x16x32_bf16 v[60:63], a[28:31], v[88:91], v[60:63]
    s_waitcnt lgkmcnt(0)
    s_nop 0
    v_cvt_pk_bf16_f32 v64, v40, v41
    v_cvt_pk_bf16_f32 v65, v42, v43
    v_mfma_f32_16x16x32_bf16 v[52:55], a[36:39], v[92:95], v[52:55]
    v_cvt_pk_bf16_f32 v66, v44, v45
    v_cvt_pk_bf16_f32 v68, v46, v47
    v_mfma_f32_16x16x32_bf16 v[56:59], a[36:39], v[96:99], v[56:59]
    v_cvt_pk_bf16_f32 v69, v48, v49
    v_cvt_pk_bf16_f32 v70, v50, v51
    v_mfma_f32_16x16x32_bf16 v[60:63], a[36:39], v[100:103], v[60:63]
    buffer_store_dwordx4 v[64:67], v2, s[40:43], s99 offen offset:0 sc1
    buffer_store_dwordx4 v[68:71], v2, s[40:43], s99 offen offset:1024 sc1
    v_cvt_pk_bf16_f32 v72, v52, v53
    v_cvt_pk_bf16_f32 v73, v54, v55
    s_nop 0
    v_cvt_pk_bf16_f32 v74, v56, v57
    buffer_store_dwordx4 v[72:75], v2, s[40:43], s99 offen offset:2048 sc1
    v_cvt_pk_bf16_f32 v76, v58, v59
    v_cvt_pk_bf16_f32 v77, v60, v61
    v_cvt_pk_bf16_f32 v78, v62, v63
    buffer_store_dwordx4 v[76:79], v2, s[40:43], s99 offen offset:3072 sc1
    s_xor_b32 s99, s99, 16384
    s_barrier
    ds_read_b128 v[80:83], v104 offset:49152
    ds_read_b128 v[84:87], v104 offset:53248
    ds_read_b128 v[88:91], v104 offset:57344
    ds_read_b128 v[92:95], v105 offset:49152
    ds_read_b128 v[96:99], v105 offset:53248
    ds_read_b128 v[100:103], v105 offset:57344
    s_waitcnt lgkmcnt(5)
    v_mfma_f32_16x16x32_bf16 v[40:43], v[112:115], v[80:83], 0
    v_mfma_f32_16x16x32_bf16 v[52:55], v[116:119], v[80:83], 0
    s_waitcnt lgkmcnt(4)
    v_mfma_f32_16x16x32_bf16 v[44:47], v[112:115], v[84:87], 0
    v_mfma_f32_16x16x32_bf16 v[56:59], v[116:119], v[84:87], 0
    s_waitcnt lgkmcnt(3)
    v_mfma_f32_16x16x32_bf16 v[48:51], v[112:115], v[88:91], 0
    v_mfma_f32_16x16x32_bf16 v[60:63], v[116:119], v[88:91], 0
    s_waitcnt lgkmcnt(2)
    ds_read_b128 v[80:83], v106 offset:49152
    v_mfma_f32_16x16x32_bf16 v[40:43], v[120:123], v[92:95], v[40:43]
    ds_read_b128 v[84:87], v106 offset:53248
    v_mfma_f32_16x16x32_bf16 v[52:55], v[124:127], v[92:95], v[52:55]
    s_waitcnt lgkmcnt(3)
    ds_read_b128 v[88:91], v106 offset:57344
    v_mfma_f32_16x16x32_bf16 v[44:47], v[120:123], v[96:99], v[44:47]
    v_mfma_f32_16x16x32_bf16 v[56:59], v[124:127], v[96:99], v[56:59]
    s_waitcnt lgkmcnt(3)
    v_mfma_f32_16x16x32_bf16 v[48:51], v[120:123], v[100:103], v[48:51]
    v_mfma_f32_16x16x32_bf16 v[60:63], v[124:127], v[100:103], v[60:63]
    s_waitcnt lgkmcnt(2)
    ds_read_b128 v[92:95], v107 offset:49152
    v_mfma_f32_16x16x32_bf16 v[40:43], v[128:131], v[80:83], v[40:43]
    ds_read_b128 v[96:99], v107 offset:53248
    v_mfma_f32_16x16x32_bf16 v[52:55], v[132:135], v[80:83], v[52:55]
    s_waitcnt lgkmcnt(3)
    ds_read_b128 v[100:103], v107 offset:57344
    v_mfma_f32_16x16x32_bf16 v[44:47], v[128:131], v[84:87], v[44:47]
    v_mfma_f32_16x16x32_bf16 v[56:59], v[132:135], v[84:87], v[56:59]
    s_waitcnt lgkmcnt(3)
    ds_read_b128 v[112:115], v108 offset:16384
    v_mfma_f32_16x16x32_bf16 v[48:51], v[128:131], v[88:91], v[48:51]
    ds_read_b128 v[116:119], v108 offset:20480
    v_mfma_f32_16x16x32_bf16 v[60:63], v[132:135], v[88:91], v[60:63]
    s_waitcnt lgkmcnt(4)
    ds_read_b128 v[120:123], v108 offset:24576
    v_mfma_f32_16x16x32_bf16 v[40:43], v[136:139], v[92:95], v[40:43]
    ds_read_b128 v[124:127], v109 offset:16384
    v_mfma_f32_16x16x32_bf16 v[52:55], v[140:143], v[92:95], v[52:55]
    s_waitcnt lgkmcnt(5)
    ds_read_b128 v[128:131], v109 offset:20480
    v_mfma_f32_16x16x32_bf16 v[44:47], v[136:139], v[96:99], v[44:47]
    ds_read_b128 v[132:135], v109 offset:24576
    v_mfma_f32_16x16x32_bf16 v[56:59], v[140:143], v[96:99], v[56:59]
    s_waitcnt lgkmcnt(6)
    v_mfma_f32_16x16x32_bf16 v[48:51], v[136:139], v[100:103], v[48:51]
    v_mfma_f32_16x16x32_bf16 v[60:63], v[140:143], v[100:103], v[60:63]
    s_waitcnt lgkmcnt(5)
    v_mfma_f32_16x16x32_bf16 v[40:43], v[144:147], v[112:115], v[40:43]
    ds_read_b128 v[80:83], v110 offset:16384
    v_mfma_f32_16x16x32_bf16 v[52:55], v[148:151], v[112:115], v[52:55]
    s_waitcnt lgkmcnt(5)
    ds_read_b128 v[84:87], v110 offset:20480
    v_mfma_f32_16x16x32_bf16 v[44:47], v[144:147], v[116:119], v[44:47]
    ds_read_b128 v[88:91], v110 offset:24576
    v_mfma_f32_16x16x32_bf16 v[56:59], v[148:151], v[116:119], v[56:59]
    s_waitcnt lgkmcnt(6)
    v_mfma_f32_16x16x32_bf16 v[48:51], v[144:147], v[120:123], v[48:51]
    v_mfma_f32_16x16x32_bf16 v[60:63], v[148:151], v[120:123], v[60:63]
    s_waitcnt lgkmcnt(5)
    v_mfma_f32_16x16x32_bf16 v[40:43], v[152:155], v[124:127], v[40:43]
    ds_read_b128 v[92:95], v111 offset:16384
    v_mfma_f32_16x16x32_bf16 v[52:55], v[156:159], v[124:127], v[52:55]
    s_waitcnt lgkmcnt(5)
    ds_read_b128 v[96:99], v111 offset:20480
    v_mfma_f32_16x16x32_bf16 v[44:47], v[152:155], v[128:131], v[44:47]
    ds_read_b128 v[100:103], v111 offset:24576
    v_mfma_f32_16x16x32_bf16 v[56:59], v[156:159], v[128:131], v[56:59]
    s_waitcnt lgkmcnt(6)
    v_mfma_f32_16x16x32_bf16 v[48:51], v[152:155], v[132:135], v[48:51]
    v_mfma_f32_16x16x32_bf16 v[60:63], v[156:159], v[132:135], v[60:63]
    s_waitcnt lgkmcnt(5)
    v_mfma_f32_16x16x32_bf16 v[40:43], v[160:163], v[80:83], v[40:43]
    s_barrier
    ds_read_b128 v[112:115], v108 offset:32768
    v_mfma_f32_16x16x32_bf16 v[52:55], v[164:167], v[80:83], v[52:55]
    s_waitcnt lgkmcnt(5)
    ds_read_b128 v[116:119], v108 offset:36864
    v_mfma_f32_16x16x32_bf16 v[44:47], v[160:163], v[84:87], v[44:47]
    ds_read_b128 v[120:123], v108 offset:40960
    v_mfma_f32_16x16x32_bf16 v[56:59], v[164:167], v[84:87], v[56:59]
    s_waitcnt lgkmcnt(6)
    v_mfma_f32_16x16x32_bf16 v[48:51], v[160:163], v[88:91], v[48:51]
    v_mfma_f32_16x16x32_bf16 v[60:63], v[164:167], v[88:91], v[60:63]
    s_waitcnt lgkmcnt(5)
    v_mfma_f32_16x16x32_bf16 v[40:43], v[168:171], v[92:95], v[40:43]
    ds_read_b128 v[124:127], v109 offset:32768
    v_mfma_f32_16x16x32_bf16 v[52:55], v[172:175], v[92:95], v[52:55]
    s_waitcnt lgkmcnt(5)
    ds_read_b128 v[128:131], v109 offset:36864
    v_mfma_f32_16x16x32_bf16 v[44:47], v[168:171], v[96:99], v[44:47]
    ds_read_b128 v[132:135], v109 offset:40960
    v_mfma_f32_16x16x32_bf16 v[56:59], v[172:175], v[96:99], v[56:59]
    s_waitcnt lgkmcnt(6)
    v_mfma_f32_16x16x32_bf16 v[48:51], v[168:171], v[100:103], v[48:51]
    v_mfma_f32_16x16x32_bf16 v[60:63], v[172:175], v[100:103], v[60:63]
    s_waitcnt lgkmcnt(5)
    v_mfma_f32_16x16x32_bf16 v[40:43], v[176:179], v[112:115], v[40:43]
    ds_read_b128 v[80:83], v110 offset:32768
    v_mfma_f32_16x16x32_bf16 v[52:55], v[180:183], v[112:115], v[52:55]
    s_waitcnt lgkmcnt(5)
    ds_read_b128 v[84:87], v110 offset:36864
    v_mfma_f32_16x16x32_bf16 v[44:47], v[176:179], v[116:119], v[44:47]
    ds_read_b128 v[88:91], v110 offset:40960
    v_mfma_f32_16x16x32_bf16 v[56:59], v[180:183], v[116:119], v[56:59]
    s_waitcnt lgkmcnt(6)
    v_mfma_f32_16x16x32_bf16 v[48:51], v[176:179], v[120:123], v[48:51]
    v_mfma_f32_16x16x32_bf16 v[60:63], v[180:183], v[120:123], v[60:63]
    s_waitcnt lgkmcnt(5)
    v_mfma_f32_16x16x32_bf16 v[40:43], v[184:187], v[124:127], v[40:43]
    ds_read_b128 v[92:95], v111 offset:32768
    v_mfma_f32_16x16x32_bf16 v[52:55], v[188:191], v[124:127], v[52:55]
    s_waitcnt lgkmcnt(5)
    ds_read_b128 v[96:99], v111 offset:36864
    v_mfma_f32_16x16x32_bf16 v[44:47], v[184:187], v[128:131], v[44:47]
    ds_read_b128 v[100:103], v111 offset:40960
    v_mfma_f32_16x16x32_bf16 v[56:59], v[188:191], v[128:131], v[56:59]
    s_waitcnt lgkmcnt(6)
    v_mfma_f32_16x16x32_bf16 v[48:51], v[184:187], v[132:135], v[48:51]
    v_mfma_f32_16x16x32_bf16 v[60:63], v[188:191], v[132:135], v[60:63]
    s_waitcnt lgkmcnt(5)
    v_mfma_f32_16x16x32_bf16 v[40:43], v[192:195], v[80:83], v[40:43]
    ds_read_b128 v[112:115], v108 offset:49152
    v_mfma_f32_16x16x32_bf16 v[52:55], v[196:199], v[80:83], v[52:55]
    s_waitcnt lgkmcnt(5)
    ds_read_b128 v[116:119], v108 offset:53248
    v_mfma_f32_16x16x32_bf16 v[44:47], v[192:195], v[84:87], v[44:47]
    ds_read_b128 v[120:123], v108 offset:57344
    v_mfma_f32_16x16x32_bf16 v[56:59], v[196:199], v[84:87], v[56:59]
    s_waitcnt lgkmcnt(6)
    v_mfma_f32_16x16x32_bf16 v[48:51], v[192:195], v[88:91], v[48:51]
    buffer_load_dwordx4 v[64:67], v2, s[40:43], s99 offen offset:0 sc1
    v_mfma_f32_16x16x32_bf16 v[60:63], v[196:199], v[88:91], v[60:63]
    s_waitcnt lgkmcnt(5)
    v_mfma_f32_16x16x32_bf16 v[40:43], a[0:3], v[92:95], v[40:43]
    ds_read_b128 v[124:127], v109 offset:49152
    buffer_load_dwordx4 v[68:71], v2, s[40:43], s99 offen offset:1024 sc1
    v_mfma_f32_16x16x32_bf16 v[52:55], a[4:7], v[92:95], v[52:55]
    s_waitcnt lgkmcnt(5)
    ds_read_b128 v[128:131], v109 offset:53248
    v_mfma_f32_16x16x32_bf16 v[44:47], a[0:3], v[96:99], v[44:47]
    ds_read_b128 v[132:135], v109 offset:57344
    buffer_load_dwordx4 v[72:75], v2, s[40:43], s99 offen offset:2048 sc1
    v_mfma_f32_16x16x32_bf16 v[56:59], a[4:7], v[96:99], v[56:59]
    s_waitcnt lgkmcnt(6)
    v_mfma_f32_16x16x32_bf16 v[48:51], a[0:3], v[100:103], v[48:51]
    buffer_load_dwordx4 v[76:79], v2, s[40:43], s99 offen offset:3072 sc1
    v_mfma_f32_16x16x32_bf16 v[60:63], a[4:7], v[100:103], v[60:63]
    s_waitcnt lgkmcnt(5)
    v_mfma_f32_16x16x32_bf16 v[40:43], a[8:11], v[112:115], v[40:43]
    ds_read_b128 v[80:83], v110 offset:49152
    v_mfma_f32_16x16x32_bf16 v[52:55], a[12:15], v[112:115], v[52:55]
    s_waitcnt lgkmcnt(5)
    ds_read_b128 v[84:87], v110 offset:53248
    v_mfma_f32_16x16x32_bf16 v[44:47], a[8:11], v[116:119], v[44:47]
    ds_read_b128 v[88:91], v110 offset:57344
    v_mfma_f32_16x16x32_bf16 v[56:59], a[12:15], v[116:119], v[56:59]
    s_waitcnt lgkmcnt(6)
    v_mfma_f32_16x16x32_bf16 v[48:51], a[8:11], v[120:123], v[48:51]
    v_mfma_f32_16x16x32_bf16 v[60:63], a[12:15], v[120:123], v[60:63]
    s_waitcnt lgkmcnt(5)
    v_mfma_f32_16x16x32_bf16 v[40:43], a[16:19], v[124:127], v[40:43]
    ds_read_b128 v[92:95], v111 offset:49152
    v_mfma_f32_16x16x32_bf16 v[52:55], a[20:23], v[124:127], v[52:55]
    s_waitcnt lgkmcnt(5)
    ds_read_b128 v[96:99], v111 offset:53248
    v_mfma_f32_16x16x32_bf16 v[44:47], a[16:19], v[128:131], v[44:47]
    ds_read_b128 v[100:103], v111 offset:57344
    v_mfma_f32_16x16x32_bf16 v[56:59], a[20:23], v[128:131], v[56:59]
    s_waitcnt lgkmcnt(6)
    v_mfma_f32_16x16x32_bf16 v[48:51], a[16:19], v[132:135], v[48:51]
    v_mfma_f32_16x16x32_bf16 v[60:63], a[20:23], v[132:135], v[60:63]
    s_waitcnt lgkmcnt(5)
    v_mfma_f32_16x16x32_bf16 v[40:43], a[24:27], v[80:83], v[40:43]
    s_waitcnt lgkmcnt(0)
    s_barrier
    v_mfma_f32_16x16x32_bf16 v[52:55], a[28:31], v[80:83], v[52:55]
    v_mfma_f32_16x16x32_bf16 v[44:47], a[24:27], v[84:87], v[44:47]
    v_mfma_f32_16x16x32_bf16 v[56:59], a[28:31], v[84:87], v[56:59]
    v_mfma_f32_16x16x32_bf16 v[48:51], a[24:27], v[88:91], v[48:51]
    v_mfma_f32_16x16x32_bf16 v[60:63], a[28:31], v[88:91], v[60:63]
    v_mfma_f32_16x16x32_bf16 v[40:43], a[32:35], v[92:95], v[40:43]
    v_mfma_f32_16x16x32_bf16 v[52:55], a[36:39], v[92:95], v[52:55]
    v_mfma_f32_16x16x32_bf16 v[44:47], a[32:35], v[96:99], v[44:47]
    v_mfma_f32_16x16x32_bf16 v[56:59], a[36:39], v[96:99], v[56:59]
    v_mfma_f32_16x16x32_bf16 v[48:51], a[32:35], v[100:103], v[48:51]
    v_mfma_f32_16x16x32_bf16 v[60:63], a[36:39], v[100:103], v[60:63]
    ds_read_b128 a[0:3], v16 offset:0
    ds_read_b128 a[4:7], v17 offset:0
    ds_read_b128 a[8:11], v18 offset:0
    ds_read_b128 a[12:15], v19 offset:0
    ds_read_b128 a[16:19], v16 offset:4096
    ds_read_b128 a[20:23], v17 offset:4096
    ds_read_b128 a[24:27], v18 offset:4096
    ds_read_b128 a[28:31], v19 offset:4096
    s_waitcnt vmcnt(1)
    v_min3_u32 v8, v67, v71, v75
    v_max3_u32 v15, v67, v71, v75
    s_waitcnt vmcnt(0)
    v_min_u32 v8, v8, v79
    v_max_u32 v15, v15, v79
    v_cmp_ne_u32 s[68:69], s55, v8
    v_cmp_ne_u32 vcc, s55, v15
    s_nop 1
    s_or_b64 vcc, vcc, s[68:69]
    s_cbranch_scc1 L_q_slow
L_q_ok:
    v_dot2_f32_bf16 v40, v64, s8, v40
    v_dot2_f32_bf16 v41, v64, s9, v41
    v_dot2_f32_bf16 v42, v65, s8, v42
    v_dot2_f32_bf16 v43, v65, s9, v43
    v_dot2_f32_bf16 v52, v72, s8, v52
    v_dot2_f32_bf16 v53, v72, s9, v53
    v_dot2_f32_bf16 v54, v73, s8, v54
    v_dot2_f32_bf16 v55, v73, s9, v55
    v_dot2_f32_bf16 v44, v66, s8, v44
    v_dot2_f32_bf16 v45, v66, s9, v45
    v_dot2_f32_bf16 v46, v68, s8, v46
    v_dot2_f32_bf16 v47, v68, s9, v47
    v_dot2_f32_bf16 v56, v74, s8, v56
    v_dot2_f32_bf16 v57, v74, s9, v57
    v_dot2_f32_bf16 v58, v76, s8, v58
    v_dot2_f32_bf16 v59, v76, s9, v59
    v_dot2_f32_bf16 v48, v69, s8, v48
    v_dot2_f32_bf16 v49, v69, s9, v49
    v_dot2_f32_bf16 v50, v70, s8, v50
    v_dot2_f32_bf16 v51, v70, s9, v51
    v_dot2_f32_bf16 v60, v77, s8, v60
    v_dot2_f32_bf16 v61, v77, s9, v61
    v_dot2_f32_bf16 v62, v78, s8, v62
    v_dot2_f32_bf16 v63, v78, s9, v63
    v_cvt_pk_bf16_f32 v184, v40, v41
    v_cvt_pk_bf16_f32 v185, v42, v43
    v_cvt_pk_bf16_f32 v186, v52, v53
    v_cvt_pk_bf16_f32 v187, v54, v55
    v_cvt_pk_bf16_f32 v188, v44, v45
    v_cvt_pk_bf16_f32 v189, v46, v47
    v_cvt_pk_bf16_f32 v190, v56, v57
    v_cvt_pk_bf16_f32 v191, v58, v59
    v_cvt_pk_bf16_f32 v192, v48, v49
    v_cvt_pk_bf16_f32 v193, v50, v51
    v_cvt_pk_bf16_f32 v194, v60, v61
    v_cvt_pk_bf16_f32 v195, v62, v63
    v_permlane16_swap_b32 v184, v186
    v_permlane16_swap_b32 v185, v187
    v_permlane16_swap_b32 v188, v190
    v_permlane16_swap_b32 v189, v191
    v_permlane16_swap_b32 v192, v194
    v_permlane16_swap_b32 v193, v195
    s_barrier
    ds_write_b128 v34, v[184:187] offset:0
    ds_write_b128 v34, v[188:191] offset:1024
    ds_write_b128 v34, v[192:195] offset:2048
    s_cmp_eq_u32 s52, 3
    s_waitcnt lgkmcnt(0)
    s_barrier
    s_cbranch_scc1 L_idle
    ds_read_b128 v[168:171], v35 offset:0
    ds_read_b128 v[172:175], v35 offset:3072
    ds_read_b128 v[176:179], v35 offset:6144
    ds_read_b128 v[180:183], v35 offset:9216
    s_waitcnt lgkmcnt(3)
    v_mfma_f32_16x16x32_bf16 v[40:43], a[0:3], v[168:171], 0
    s_waitcnt lgkmcnt(2)
    ds_read_b128 a[32:35], v16 offset:8192
    v_mfma_f32_16x16x32_bf16 v[40:43], a[4:7], v[172:175], v[40:43]
    s_waitcnt lgkmcnt(2)
    ds_read_b128 a[36:39], v17 offset:8192
    v_mfma_f32_16x16x32_bf16 v[40:43], a[8:11], v[176:179], v[40:43]
    s_waitcnt lgkmcnt(2)
    ds_read_b128 a[40:43], v18 offset:8192
    v_mfma_f32_16x16x32_bf16 v[40:43], a[12:15], v[180:183], v[40:43]
    ds_read_b128 a[44:47], v19 offset:8192
    v_mfma_f32_16x16x32_bf16 v[44:47], a[16:19], v[168:171], 0
    ds_read_b128 a[0:3], v16 offset:12288
    v_mfma_f32_16x16x32_bf16 v[44:47], a[20:23], v[172:175], v[44:47]
    ds_read_b128 a[4:7], v17 offset:12288
    v_mfma_f32_16x16x32_bf16 v[44:47], a[24:27], v[176:179], v[44:47]
    ds_read_b128 a[8:11], v18 offset:12288
    v_mfma_f32_16x16x32_bf16 v[44:47], a[28:31], v[180:183], v[44:47]
    s_waitcnt lgkmcnt(6)
    ds_read_b128 a[12:15], v19 offset:12288
    v_mfma_f32_16x16x32_bf16 v[48:51], a[32:35], v[168:171], 0
    s_waitcnt lgkmcnt(6)
    ds_read_b128 a[16:19], v20 offset:0
    v_max3_f32 v32, v40, v41, v42
    v_mfma_f32_16x16x32_bf16 v[48:51], a[36:39], v[172:175], v[48:51]
    s_waitcnt lgkmcnt(6)
    ds_read_b128 a[20:23], v21 offset:0
    v_mfma_f32_16x16x32_bf16 v[48:51], a[40:43], v[176:179], v[48:51]
    s_waitcnt lgkmcnt(6)
    ds_read_b128 a[24:27], v22 offset:0
    v_max_f32 v33, v43, v43
    v_mfma_f32_16x16x32_bf16 v[48:51], a[44:47], v[180:183], v[48:51]
    s_waitcnt lgkmcnt(6)
    ds_read_b128 a[28:31], v23 offset:0
    v_mfma_f32_16x16x32_bf16 v[52:55], a[0:3], v[168:171], 0
    s_waitcnt lgkmcnt(6)
    ds_read_b128 a[32:35], v20 offset:4096
    v_max3_f32 v32, v32, v44, v45
    v_mfma_f32_16x16x32_bf16 v[52:55], a[4:7], v[172:175], v[52:55]
    s_waitcnt lgkmcnt(6)
    ds_read_b128 a[36:39], v21 offset:4096
    v_mfma_f32_16x16x32_bf16 v[52:55], a[8:11], v[176:179], v[52:55]
    s_waitcnt lgkmcnt(6)
    ds_read_b128 a[40:43], v22 offset:4096
    v_max3_f32 v33, v33, v46, v47
    v_mfma_f32_16x16x32_bf16 v[52:55], a[12:15], v[180:183], v[52:55]
    s_waitcnt lgkmcnt(6)
    ds_read_b128 a[44:47], v23 offset:4096
    v_mfma_f32_16x16x32_bf16 v[56:59], a[16:19], v[168:171], 0
    s_waitcnt lgkmcnt(6)
    ds_read_b128 a[0:3], v20 offset:8192
    v_max3_f32 v32, v32, v48, v49
    v_mfma_f32_16x16x32_bf16 v[56:59], a[20:23], v[172:175], v[56:59]
    s_waitcnt lgkmcnt(6)
    ds_read_b128 a[4:7], v21 offset:8192
    v_mfma_f32_16x16x32_bf16 v[56:59], a[24:27], v[176:179], v[56:59]
    s_waitcnt lgkmcnt(6)
    ds_read_b128 a[8:11], v22 offset:8192
    v_max3_f32 v33, v33, v50, v51
    v_mfma_f32_16x16x32_bf16 v[56:59], a[28:31], v[180:183], v[56:59]
    s_waitcnt lgkmcnt(6)
    ds_read_b128 a[12:15], v23 offset:8192
    v_mfma_f32_16x16x32_bf16 v[60:63], a[32:35], v[168:171], 0
    s_waitcnt lgkmcnt(6)
    ds_read_b128 a[16:19], v20 offset:12288
    v_max3_f32 v32, v32, v52, v53
    v_mfma_f32_16x16x32_bf16 v[60:63], a[36:39], v[172:175], v[60:63]
    s_waitcnt lgkmcnt(6)
    ds_read_b128 a[20:23], v21 offset:12288
    v_mfma_f32_16x16x32_bf16 v[60:63], a[40:43], v[176:179], v[60:63]
    s_waitcnt lgkmcnt(6)
    ds_read_b128 a[24:27], v22 offset:12288
    v_max3_f32 v33, v33, v54, v55
    v_mfma_f32_16x16x32_bf16 v[60:63], a[44:47], v[180:183], v[60:63]
    s_waitcnt lgkmcnt(6)
    ds_read_b128 a[28:31], v23 offset:12288
    v_mfma_f32_16x16x32_bf16 v[64:67], a[0:3], v[168:171], 0
    s_waitcnt lgkmcnt(6)
    s_barrier
    ds_read_b128 a[32:35], v16 offset:16384
    v_max3_f32 v32, v32, v56, v57
    v_mfma_f32_16x16x32_bf16 v[64:67], a[4:7], v[172:175], v[64:67]
    s_waitcnt lgkmcnt(6)
    ds_read_b128 a[36:39], v17 offset:16384
    v_mfma_f32_16x16x32_bf16 v[64:67], a[8:11], v[176:179], v[64:67]
    s_waitcnt lgkmcnt(6)
    ds_read_b128 a[40:43], v18 offset:16384
    v_max3_f32 v33, v33, v58, v59
    v_mfma_f32_16x16x32_bf16 v[64:67], a[12:15], v[180:183], v[64:67]
    s_waitcnt lgkmcnt(6)
    ds_read_b128 a[44:47], v19 offset:16384
    v_mfma_f32_16x16x32_bf16 v[68:71], a[16:19], v[168:171], 0
    s_waitcnt lgkmcnt(6)
    ds_read_b128 a[0:3], v16 offset:20480
    v_max3_f32 v32, v32, v60, v61
    v_mfma_f32_16x16x32_bf16 v[68:71], a[20:23], v[172:175], v[68:71]
    s_waitcnt lgkmcnt(6)
    ds_read_b128 a[4:7], v17 offset:20480
    v_mfma_f32_16x16x32_bf16 v[68:71], a[24:27], v[176:179], v[68:71]
    s_waitcnt lgkmcnt(6)
    ds_read_b128 a[8:11], v18 offset:20480
    v_max3_f32 v33, v33, v62, v63
    v_mfma_f32_16x16x32_bf16 v[68:71], a[28:31], v[180:183], v[68:71]
    s_waitcnt lgkmcnt(6)
    ds_read_b128 a[12:15], v19 offset:20480
    v_mfma_f32_16x16x32_bf16 v[72:75], a[32:35], v[168:171], 0
    s_waitcnt lgkmcnt(6)
    ds_read_b128 a[16:19], v16 offset:24576
    v_max3_f32 v32, v32, v64, v65
    v_mfma_f32_16x16x32_bf16 v[72:75], a[36:39], v[172:175], v[72:75]
    s_waitcnt lgkmcnt(6)
    ds_read_b128 a[20:23], v17 offset:24576
    v_mfma_f32_16x16x32_bf16 v[72:75], a[40:43], v[176:179], v[72:75]
    s_waitcnt lgkmcnt(6)
    ds_read_b128 a[24:27], v18 offset:24576
    v_max3_f32 v33, v33, v66, v67
    v_mfma_f32_16x16x32_bf16 v[72:75], a[44:47], v[180:183], v[72:75]
    s_waitcnt lgkmcnt(6)
    ds_read_b128 a[28:31], v19 offset:24576
    v_mfma_f32_16x16x32_bf16 v[76:79], a[0:3], v[168:171], 0
    s_waitcnt lgkmcnt(6)
    ds_read_b128 a[32:35], v16 offset:28672
    v_max3_f32 v32, v32, v68, v69
    v_mfma_f32_16x16x32_bf16 v[76:79], a[4:7], v[172:175], v[76:79]
    s_waitcnt lgkmcnt(6)
    ds_read_b128 a[36:39], v17 offset:28672
    v_mfma_f32_16x16x32_bf16 v[76:79], a[8:11], v[176:179], v[76:79]
    s_waitcnt lgkmcnt(6)
    ds_read_b128 a[40:43], v18 offset:28672
    v_max3_f32 v33, v33, v70, v71
    v_mfma_f32_16x16x32_bf16 v[76:79], a[12:15], v[180:183], v[76:79]
    s_waitcnt lgkmcnt(6)
    ds_read_b128 a[44:47], v19 offset:28672
    v_mfma_f32_16x16x32_bf16 v[80:83], a[16:19], v[168:171], 0
    s_waitcnt lgkmcnt(6)
    ds_read_b128 a[0:3], v16 offset:32768
    v_max3_f32 v32, v32, v72, v73
    v_mfma_f32_16x16x32_bf16 v[80:83], a[20:23], v[172:175], v[80:83]
    s_waitcnt lgkmcnt(6)
    ds_read_b128 a[4:7], v17 offset:32768
    v_mfma_f32_16x16x32_bf16 v[80:83], a[24:27], v[176:179], v[80:83]
    s_waitcnt lgkmcnt(6)
    ds_read_b128 a[8:11], v18 offset:32768
    v_max3_f32 v33, v33, v74, v75
    v_mfma_f32_16x16x32_bf16 v[80:83], a[28:31], v[180:183], v[80:83]
    s_waitcnt lgkmcnt(6)
    ds_read_b128 a[12:15], v19 offset:32768
    v_mfma_f32_16x16x32_bf16 v[84:87], a[32:35], v[168:171], 0
    s_waitcnt lgkmcnt(6)
    ds_read_b128 a[16:19], v16 offset:36864
    v_max3_f32 v32, v32, v76, v77
    v_mfma_f32_16x16x32_bf16 v[84:87], a[36:39], v[172:175], v[84:87]
    s_waitcnt lgkmcnt(6)
    ds_read_b128 a[20:23], v17 offset:36864
    v_mfma_f32_16x16x32_bf16 v[84:87], a[40:43], v[176:179], v[84:87]
    s_waitcnt lgkmcnt(6)
    ds_read_b128 a[24:27], v18 offset:36864
    v_max3_f32 v33, v33, v78, v79
    v_mfma_f32_16x16x32_bf16 v[84:87], a[44:47], v[180:183], v[84:87]
    s_waitcnt lgkmcnt(6)
    ds_read_b128 a[28:31], v19 offset:36864
    v_mfma_f32_16x16x32_bf16 v[88:91], a[0:3], v[168:171], 0
    s_waitcnt lgkmcnt(6)
    ds_read_b128 a[32:35], v16 offset:40960
    v_max3_f32 v32, v32, v80, v81
    v_mfma_f32_16x16x32_bf16 v[88:91], a[4:7], v[172:175], v[88:91]
    s_waitcnt lgkmcnt(6)
    ds_read_b128 a[36:39], v17 offset:40960
    v_mfma_f32_16x16x32_bf16 v[88:91], a[8:11], v[176:179], v[88:91]
    s_waitcnt lgkmcnt(6)
    ds_read_b128 a[40:43], v18 offset:40960
    v_max3_f32 v33, v33, v82, v83
    v_mfma_f32_16x16x32_bf16 v[88:91], a[12:15], v[180:183], v[88:91]
    s_waitcnt lgkmcnt(6)
    ds_read_b128 a[44:47], v19 offset:40960
    v_mfma_f32_16x16x32_bf16 v[92:95], a[16:19], v[168:171], 0
    s_waitcnt lgkmcnt(6)
    ds_read_b128 a[0:3], v16 offset:45056
    v_max3_f32 v32, v32, v84, v85
    v_mfma_f32_16x16x32_bf16 v[92:95], a[20:23], v[172:175], v[92:95]
    s_waitcnt lgkmcnt(6)
    ds_read_b128 a[4:7], v17 offset:45056
    v_mfma_f32_16x16x32_bf16 v[92:95], a[24:27], v[176:179], v[92:95]
    s_waitcnt lgkmcnt(6)
    ds_read_b128 a[8:11], v18 offset:45056
    v_max3_f32 v33, v33, v86, v87
    v_mfma_f32_16x16x32_bf16 v[92:95], a[28:31], v[180:183], v[92:95]
    s_waitcnt lgkmcnt(6)
    ds_read_b128 a[12:15], v19 offset:45056
    v_mfma_f32_16x16x32_bf16 v[96:99], a[32:35], v[168:171], 0
    s_waitcnt lgkmcnt(6)
    s_barrier
    ds_read_b128 a[16:19], v16 offset:49152
    v_max3_f32 v32, v32, v88, v89
    v_mfma_f32_16x16x32_bf16 v[96:99], a[36:39], v[172:175], v[96:99]
    s_waitcnt lgkmcnt(6)
    ds_read_b128 a[20:23], v17 offset:49152
    v_mfma_f32_16x16x32_bf16 v[96:99], a[40:43], v[176:179], v[96:99]
    s_waitcnt lgkmcnt(6)
    ds_read_b128 a[24:27], v18 offset:49152
    v_max3_f32 v33, v33, v90, v91
    v_mfma_f32_16x16x32_bf16 v[96:99], a[44:47], v[180:183], v[96:99]
    s_waitcnt lgkmcnt(6)
    ds_read_b128 a[28:31], v19 offset:49152
    v_mfma_f32_16x16x32_bf16 v[100:103], a[0:3], v[168:171], 0
    s_waitcnt lgkmcnt(6)
    ds_read_b128 a[32:35], v16 offset:53248
    v_max3_f32 v32, v32, v92, v93
    v_mfma_f32_16x16x32_bf16 v[100:103], a[4:7], v[172:175], v[100:103]
    s_waitcnt lgkmcnt(6)
    ds_read_b128 a[36:39], v17 offset:53248
    v_mfma_f32_16x16x32_bf16 v[100:103], a[8:11], v[176:179], v[100:103]
    s_waitcnt lgkmcnt(6)
    ds_read_b128 a[40:43], v18 offset:53248
    v_max3_f32 v33, v33, v94, v95
    v_mfma_f32_16x16x32_bf16 v[100:103], a[12:15], v[180:183], v[100:103]
    s_waitcnt lgkmcnt(6)
    ds_read_b128 a[44:47], v19 offset:53248
    v_mfma_f32_16x16x32_bf16 v[104:107], a[16:19], v[168:171], 0
    s_waitcnt lgkmcnt(6)
    ds_read_b128 a[0:3], v16 offset:57344
    v_max3_f32 v32, v32, v96, v97
    v_mfma_f32_16x16x32_bf16 v[104:107], a[20:23], v[172:175], v[104:107]
    s_waitcnt lgkmcnt(6)
    ds_read_b128 a[4:7], v17 offset:57344
    v_mfma_f32_16x16x32_bf16 v[104:107], a[24:27], v[176:179], v[104:107]
    s_waitcnt lgkmcnt(6)
    ds_read_b128 a[8:11], v18 offset:57344
    v_max3_f32 v33, v33, v98, v99
    v_mfma_f32_16x16x32_bf16 v[104:107], a[28:31], v[180:183], v[104:107]
    s_waitcnt lgkmcnt(6)
    ds_read_b128 a[12:15], v19 offset:57344
    v_mfma_f32_16x16x32_bf16 v[108:111], a[32:35], v[168:171], 0
    s_waitcnt lgkmcnt(6)
    ds_read_b128 a[16:19], v16 offset:61440
    v_max3_f32 v32, v32, v100, v101
    v_mfma_f32_16x16x32_bf16 v[108:111], a[36:39], v[172:175], v[108:111]
    s_waitcnt lgkmcnt(6)
    ds_read_b128 a[20:23], v17 offset:61440
    v_mfma_f32_16x16x32_bf16 v[108:111], a[40:43], v[176:179], v[108:111]
    s_waitcnt lgkmcnt(6)
    ds_read_b128 a[24:27], v18 offset:61440
    v_max3_f32 v33, v33, v102, v103
    v_mfma_f32_16x16x32_bf16 v[108:111], a[44:47], v[180:183], v[108:111]
    s_waitcnt lgkmcnt(6)
    ds_read_b128 a[28:31], v19 offset:61440
    v_mfma_f32_16x16x32_bf16 v[112:115], a[0:3], v[168:171], 0
    s_waitcnt lgkmcnt(6)
    ds_read_b128 a[32:35], v20 offset:16384
    v_max3_f32 v32, v32, v104, v105
    v_mfma_f32_16x16x32_bf16 v[112:115], a[4:7], v[172:175], v[112:115]
    s_waitcnt lgkmcnt(6)
    ds_read_b128 a[36:39], v21 offset:16384
    v_mfma_f32_16x16x32_bf16 v[112:115], a[8:11], v[176:179], v[112:115]
    s_waitcnt lgkmcnt(6)
    ds_read_b128 a[40:43], v22 offset:16384
    v_max3_f32 v33, v33, v106, v107
    v_mfma_f32_16x16x32_bf16 v[112:115], a[12:15], v[180:183], v[112:115]
    s_waitcnt lgkmcnt(6)
    ds_read_b128 a[44:47], v23 offset:16384
    v_mfma_f32_16x16x32_bf16 v[116:119], a[16:19], v[168:171], 0
    s_waitcnt lgkmcnt(6)
    ds_read_b128 a[0:3], v20 offset:20480
    v_max3_f32 v32, v32, v108, v109
    v_mfma_f32_16x16x32_bf16 v[116:119], a[20:23], v[172:175], v[116:119]
    s_waitcnt lgkmcnt(6)
    ds_read_b128 a[4:7], v21 offset:20480
    v_mfma_f32_16x16x32_bf16 v[116:119], a[24:27], v[176:179], v[116:119]
    s_waitcnt lgkmcnt(6)
    ds_read_b128 a[8:11], v22 offset:20480
    v_max3_f32 v33, v33, v110, v111
    v_mfma_f32_16x16x32_bf16 v[116:119], a[28:31], v[180:183], v[116:119]
    s_waitcnt lgkmcnt(6)
    ds_read_b128 a[12:15], v23 offset:20480
    v_mfma_f32_16x16x32_bf16 v[120:123], a[32:35], v[168:171], 0
    s_waitcnt lgkmcnt(6)
    ds_read_b128 a[16:19], v20 offset:24576
    v_max3_f32 v32, v32, v112, v113
    v_mfma_f32_16x16x32_bf16 v[120:123], a[36:39], v[172:175], v[120:123]
    s_waitcnt lgkmcnt(6)
    ds_read_b128 a[20:23], v21 offset:24576
    v_mfma_f32_16x16x32_bf16 v[120:123], a[40:43], v[176:179], v[120:123]
    s_waitcnt lgkmcnt(6)
    ds_read_b128 a[24:27], v22 offset:24576
    v_max3_f32 v33, v33, v114, v115
    v_mfma_f32_16x16x32_bf16 v[120:123], a[44:47], v[180:183], v[120:123]
    s_waitcnt lgkmcnt(6)
    ds_read_b128 a[28:31], v23 offset:24576
    v_mfma_f32_16x16x32_bf16 v[124:127], a[0:3], v[168:171], 0
    s_waitcnt lgkmcnt(6)
    ds_read_b128 a[32:35], v20 offset:28672
    v_max3_f32 v32, v32, v116, v117
    v_mfma_f32_16x16x32_bf16 v[124:127], a[4:7], v[172:175], v[124:127]
    s_waitcnt lgkmcnt(6)
    ds_read_b128 a[36:39], v21 offset:28672
    v_mfma_f32_16x16x32_bf16 v[124:127], a[8:11], v[176:179], v[124:127]
    s_waitcnt lgkmcnt(6)
    ds_read_b128 a[40:43], v22 offset:28672
    v_max3_f32 v33, v33, v118, v119
    v_mfma_f32_16x16x32_bf16 v[124:127], a[12:15], v[180:183], v[124:127]
    s_waitcnt lgkmcnt(6)
    ds_read_b128 a[44:47], v23 offset:28672
    v_mfma_f32_16x16x32_bf16 v[128:131], a[16:19], v[168:171], 0
    s_waitcnt lgkmcnt(6)
    s_barrier
    ds_read_b128 a[0:3], v20 offset:32768
    v_max3_f32 v32, v32, v120, v121
    v_mfma_f32_16x16x32_bf16 v[128:131], a[20:23], v[172:175], v[128:131]
    s_waitcnt lgkmcnt(6)
    ds_read_b128 a[4:7], v21 offset:32768
    v_mfma_f32_16x16x32_bf16 v[128:131], a[24:27], v[176:179], v[128:131]
    s_waitcnt lgkmcnt(6)
    ds_read_b128 a[8:11], v22 offset:32768
    v_max3_f32 v33, v33, v122, v123
    v_mfma_f32_16x16x32_bf16 v[128:131], a[28:31], v[180:183], v[128:131]
    s_waitcnt lgkmcnt(6)
    ds_read_b128 a[12:15], v23 offset:32768
    v_mfma_f32_16x16x32_bf16 v[132:135], a[32:35], v[168:171], 0
    s_waitcnt lgkmcnt(6)
    ds_read_b128 a[16:19], v20 offset:36864
    v_max3_f32 v32, v32, v124, v125
    v_mfma_f32_16x16x32_bf16 v[132:135], a[36:39], v[172:175], v[132:135]
    s_waitcnt lgkmcnt(6)
    ds_read_b128 a[20:23], v21 offset:36864
    v_mfma_f32_16x16x32_bf16 v[132:135], a[40:43], v[176:179], v[132:135]
    s_waitcnt lgkmcnt(6)
    ds_read_b128 a[24:27], v22 offset:36864
    v_max3_f32 v33, v33, v126, v127
    v_mfma_f32_16x16x32_bf16 v[132:135], a[44:47], v[180:183], v[132:135]
    s_waitcnt lgkmcnt(6)
    ds_read_b128 a[28:31], v23 offset:36864
    v_mfma_f32_16x16x32_bf16 v[136:139], a[0:3], v[168:171], 0
    s_waitcnt lgkmcnt(6)
    ds_read_b128 a[32:35], v20 offset:40960
    v_max3_f32 v32, v32, v128, v129
    v_mfma_f32_16x16x32_bf16 v[136:139], a[4:7], v[172:175], v[136:139]
    s_waitcnt lgkmcnt(6)
    ds_read_b128 a[36:39], v21 offset:40960
    v_mfma_f32_16x16x32_bf16 v[136:139], a[8:11], v[176:179], v[136:139]
    s_waitcnt lgkmcnt(6)
    ds_read_b128 a[40:43], v22 offset:40960
    v_max3_f32 v33, v33, v130, v131
    v_mfma_f32_16x16x32_bf16 v[136:139], a[12:15], v[180:183], v[136:139]
    s_waitcnt lgkmcnt(6)
    ds_read_b128 a[44:47], v23 offset:40960
    v_mfma_f32_16x16x32_bf16 v[140:143], a[16:19], v[168:171], 0
    s_waitcnt lgkmcnt(6)
    ds_read_b128 a[0:3], v20 offset:45056
    v_max3_f32 v32, v32, v132, v133
    v_mfma_f32_16x16x32_bf16 v[140:143], a[20:23], v[172:175], v[140:143]
    s_waitcnt lgkmcnt(6)
    ds_read_b128 a[4:7], v21 offset:45056
    v_mfma_f32_16x16x32_bf16 v[140:143], a[24:27], v[176:179], v[140:143]
    s_waitcnt lgkmcnt(6)
    ds_read_b128 a[8:11], v22 offset:45056
    v_max3_f32 v33, v33, v134, v135
    v_mfma_f32_16x16x32_bf16 v[140:143], a[28:31], v[180:183], v[140:143]
    s_waitcnt lgkmcnt(6)
    ds_read_b128 a[12:15], v23 offset:45056
    v_mfma_f32_16x16x32_bf16 v[144:147], a[32:35], v[168:171], 0
    s_waitcnt lgkmcnt(6)
    ds_read_b128 a[16:19], v20 offset:49152
    v_max3_f32 v32, v32, v136, v137
    v_mfma_f32_16x16x32_bf16 v[144:147], a[36:39], v[172:175], v[144:147]
    s_waitcnt lgkmcnt(6)
    ds_read_b128 a[20:23], v21 offset:49152
    v_mfma_f32_16x16x32_bf16 v[144:147], a[40:43], v[176:179], v[144:147]
    s_waitcnt lgkmcnt(6)
    ds_read_b128 a[24:27], v22 offset:49152
    v_max3_f32 v33, v33, v138, v139
    v_mfma_f32_16x16x32_bf16 v[144:147], a[44:47], v[180:183], v[144:147]
    s_waitcnt lgkmcnt(6)
    ds_read_b128 a[28:31], v23 offset:49152
    v_mfma_f32_16x16x32_bf16 v[148:151], a[0:3], v[168:171], 0
    s_waitcnt lgkmcnt(6)
    ds_read_b128 a[32:35], v20 offset:53248
    v_max3_f32 v32, v32, v140, v141
    v_mfma_f32_16x16x32_bf16 v[148:151], a[4:7], v[172:175], v[148:151]
L_pg0:
    s_cbranch_execz L_pgr0
    s_waitcnt lgkmcnt(6)
    ds_read_b128 a[36:39], v21 offset:53248
    v_mfma_f32_16x16x32_bf16 v[148:151], a[8:11], v[176:179], v[148:151]
    s_waitcnt lgkmcnt(6)
    ds_read_b128 a[40:43], v22 offset:53248
    v_max3_f32 v33, v33, v142, v143
    v_mfma_f32_16x16x32_bf16 v[148:151], a[12:15], v[180:183], v[148:151]
    s_waitcnt lgkmcnt(6)
    ds_read_b128 a[44:47], v23 offset:53248
    v_mfma_f32_16x16x32_bf16 v[152:155], a[16:19], v[168:171], 0
    s_waitcnt lgkmcnt(6)
    ds_read_b128 a[0:3], v20 offset:57344
    v_max3_f32 v32, v32, v144, v145
    v_mfma_f32_16x16x32_bf16 v[152:155], a[20:23], v[172:175], v[152:155]
    s_waitcnt lgkmcnt(6)
    ds_read_b128 a[4:7], v21 offset:57344
    v_mfma_f32_16x16x32_bf16 v[152:155], a[24:27], v[176:179], v[152:155]
    s_waitcnt lgkmcnt(6)
    ds_read_b128 a[8:11], v22 offset:57344
    v_max3_f32 v33, v33, v146, v147
    v_mfma_f32_16x16x32_bf16 v[152:155], a[28:31], v[180:183], v[152:155]
    s_waitcnt lgkmcnt(6)
    ds_read_b128 a[12:15], v23 offset:57344
    v_mfma_f32_16x16x32_bf16 v[156:159], a[32:35], v[168:171], 0
    s_waitcnt lgkmcnt(6)
    ds_read_b128 a[16:19], v20 offset:61440
    v_max3_f32 v32, v32, v148, v149
    v_mfma_f32_16x16x32_bf16 v[156:159], a[36:39], v[172:175], v[156:159]
    s_waitcnt lgkmcnt(6)
    ds_read_b128 a[20:23], v21 offset:61440
    v_mfma_f32_16x16x32_bf16 v[156:159], a[40:43], v[176:179], v[156:159]
    s_waitcnt lgkmcnt(6)
    ds_read_b128 a[24:27], v22 offset:61440
    v_max3_f32 v33, v33, v150, v151
    v_mfma_f32_16x16x32_bf16 v[156:159], a[44:47], v[180:183], v[156:159]
    s_waitcnt lgkmcnt(6)
    ds_read_b128 a[28:31], v23 offset:61440
    v_mfma_f32_16x16x32_bf16 v[160:163], a[0:3], v[168:171], 0
    s_waitcnt lgkmcnt(6)
    v_max3_f32 v32, v32, v152, v153
    v_mfma_f32_16x16x32_bf16 v[160:163], a[4:7], v[172:175], v[160:163]
    s_waitcnt lgkmcnt(5)
    v_mfma_f32_16x16x32_bf16 v[160:163], a[8:11], v[176:179], v[160:163]
    s_waitcnt lgkmcnt(4)
    v_max3_f32 v33, v33, v154, v155
    v_mfma_f32_16x16x32_bf16 v[160:163], a[12:15], v[180:183], v[160:163]
    s_waitcnt lgkmcnt(3)
    v_mfma_f32_16x16x32_bf16 v[164:167], a[16:19], v[168:171], 0
    s_waitcnt lgkmcnt(2)
    v_max3_f32 v32, v32, v156, v157
    v_mfma_f32_16x16x32_bf16 v[164:167], a[20:23], v[172:175], v[164:167]
    s_waitcnt lgkmcnt(1)
    v_mfma_f32_16x16x32_bf16 v[164:167], a[24:27], v[176:179], v[164:167]
    s_waitcnt lgkmcnt(0)
    v_max3_f32 v33, v33, v158, v159
    v_mfma_f32_16x16x32_bf16 v[164:167], a[28:31], v[180:183], v[164:167]
    v_max3_f32 v32, v32, v160, v161
    v_max3_f32 v33, v33, v162, v163
    s_nop 5
    v_max3_f32 v32, v32, v164, v165
    v_max3_f32 v33, v33, v166, v167
    v_max_f32 v32, v32, v33
    v_mov_b32 v36, v32
    s_nop 1
    v_permlane16_swap_b32 v32, v36
    v_max_f32 v32, v32, v36
    v_mov_b32 v36, v32
    s_nop 1
    v_permlane32_swap_b32 v32, v36
    v_max_f32 v36, v32, v36
    v_mul_f32 v32, s66, -v36
    v_mul_f32 v33, s66, -v36
    v_pk_fma_f32 v[40:41], v[40:41], s[66:67], v[32:33]
    v_pk_fma_f32 v[42:43], v[42:43], s[66:67], v[32:33]
    v_pk_fma_f32 v[44:45], v[44:45], s[66:67], v[32:33]
    v_pk_fma_f32 v[46:47], v[46:47], s[66:67], v[32:33]
    v_pk_fma_f32 v[48:49], v[48:49], s[66:67], v[32:33]
    v_pk_fma_f32 v[50:51], v[50:51], s[66:67], v[32:33]
    v_pk_fma_f32 v[52:53], v[52:53], s[66:67], v[32:33]
    v_pk_fma_f32 v[54:55], v[54:55], s[66:67], v[32:33]
    v_pk_fma_f32 v[56:57], v[56:57], s[66:67], v[32:33]
    v_pk_fma_f32 v[58:59], v[58:59], s[66:67], v[32:33]
    v_pk_fma_f32 v[60:61], v[60:61], s[66:67], v[32:33]
    v_pk_fma_f32 v[62:63], v[62:63], s[66:67], v[32:33]
    v_pk_fma_f32 v[64:65], v[64:65], s[66:67], v[32:33]
    v_pk_fma_f32 v[66:67], v[66:67], s[66:67], v[32:33]
    v_pk_fma_f32 v[68:69], v[68:69], s[66:67], v[32:33]
    v_pk_fma_f32 v[70:71], v[70:71], s[66:67], v[32:33]
    v_pk_fma_f32 v[72:73], v[72:73], s[66:67], v[32:33]
    v_pk_fma_f32 v[74:75], v[74:75], s[66:67], v[32:33]
    v_pk_fma_f32 v[76:77], v[76:77], s[66:67], v[32:33]
    v_pk_fma_f32 v[78:79], v[78:79], s[66:67], v[32:33]
    v_pk_fma_f32 v[80:81], v[80:81], s[66:67], v[32:33]
    v_pk_fma_f32 v[82:83], v[82:83], s[66:67], v[32:33]
    v_pk_fma_f32 v[84:85], v[84:85], s[66:67], v[32:33]
    v_pk_fma_f32 v[86:87], v[86:87], s[66:67], v[32:33]
    v_pk_fma_f32 v[88:89], v[88:89], s[66:67], v[32:33]
    v_pk_fma_f32 v[90:91], v[90:91], s[66:67], v[32:33]
    v_pk_fma_f32 v[92:93], v[92:93], s[66:67], v[32:33]
    v_pk_fma_f32 v[94:95], v[94:95], s[66:67], v[32:33]
    v_pk_fma_f32 v[96:97], v[96:97], s[66:67], v[32:33]
    v_pk_fma_f32 v[98:99], v[98:99], s[66:67], v[32:33]
    v_pk_fma_f32 v[100:101], v[100:101], s[66:67], v[32:33]
    v_pk_fma_f32 v[102:103], v[102:103], s[66:67], v[32:33]
    v_pk_fma_f32 v[104:105], v[104:105], s[66:67], v[32:33]
    v_pk_fma_f32 v[106:107], v[106:107], s[66:67], v[32:33]
    v_pk_fma_f32 v[108:109], v[108:109], s[66:67], v[32:33]
    v_pk_fma_f32 v[110:111], v[110:111], s[66:67], v[32:33]
    v_pk_fma_f32 v[112:113], v[112:113], s[66:67], v[32:33]
    v_pk_fma_f32 v[114:115], v[114:115], s[66:67], v[32:33]
    v_pk_fma_f32 v[116:117], v[116:117], s[66:67], v[32:33]
    v_pk_fma_f32 v[118:119], v[118:119], s[66:67], v[32:33]
    v_pk_fma_f32 v[120:121], v[120:121], s[66:67], v[32:33]
    v_pk_fma_f32 v[122:123], v[122:123], s[66:67], v[32:33]
    v_pk_fma_f32 v[124:125], v[124:125], s[66:67], v[32:33]
    v_pk_fma_f32 v[126:127], v[126:127], s[66:67], v[32:33]
    v_pk_fma_f32 v[128:129], v[128:129], s[66:67], v[32:33]
    v_pk_fma_f32 v[130:131], v[130:131], s[66:67], v[32:33]
    v_pk_fma_f32 v[132:133], v[132:133], s[66:67], v[32:33]
    v_pk_fma_f32 v[134:135], v[134:135], s[66:67], v[32:33]
    v_pk_fma_f32 v[136:137], v[136:137], s[66:67], v[32:33]
    v_pk_fma_f32 v[138:139], v[138:139], s[66:67], v[32:33]
    v_pk_fma_f32 v[140:141], v[140:141], s[66:67], v[32:33]
    v_pk_fma_f32 v[142:143], v[142:143], s[66:67], v[32:33]
    v_pk_fma_f32 v[144:145], v[144:145], s[66:67], v[32:33]
    v_pk_fma_f32 v[146:147], v[146:147], s[66:67], v[32:33]
    v_pk_fma_f32 v[148:149], v[148:149], s[66:67], v[32:33]
    v_pk_fma_f32 v[150:151], v[150:151], s[66:67], v[32:33]
    v_pk_fma_f32 v[152:153], v[152:153], s[66:67], v[32:33]
    v_pk_fma_f32 v[154:155], v[154:155], s[66:67], v[32:33]
    v_pk_fma_f32 v[156:157], v[156:157], s[66:67], v[32:33]
    v_pk_fma_f32 v[158:159], v[158:159], s[66:67], v[32:33]
    v_pk_fma_f32 v[160:161], v[160:161], s[66:67], v[32:33]
    v_pk_fma_f32 v[162:163], v[162:163], s[66:67], v[32:33]
    v_pk_fma_f32 v[164:165], v[164:165], s[66:67], v[32:33]
    v_pk_fma_f32 v[166:167], v[166:167], s[66:67], v[32:33]
    v_exp_f32 v40, v40
    v_exp_f32 v41, v41
    v_exp_f32 v42, v42
    v_exp_f32 v43, v43
    v_exp_f32 v44, v44
    v_exp_f32 v45, v45
    v_exp_f32 v46, v46
    v_exp_f32 v47, v47
    v_cvt_pk_bf16_f32 v40, v40, v41
    v_cvt_pk_bf16_f32 v41, v42, v43
    v_cvt_pk_bf16_f32 v42, v44, v45
    v_cvt_pk_bf16_f32 v43, v46, v47
    s_barrier
    ds_read_b64_tr_b16 a[0:1], v24 offset:0
    ds_read_b64_tr_b16 a[2:3], v24 offset:2048
    ds_read_b64_tr_b16 a[4:5], v25 offset:0
    ds_read_b64_tr_b16 a[6:7], v25 offset:2048
    ds_read_b64_tr_b16 a[8:9], v26 offset:0
    ds_read_b64_tr_b16 a[10:11], v26 offset:2048
    ds_read_b64_tr_b16 a[12:13], v27 offset:0
    ds_read_b64_tr_b16 a[14:15], v27 offset:2048
    ds_read_b64_tr_b16 a[16:17], v24 offset:4096
    ds_read_b64_tr_b16 a[18:19], v24 offset:6144
    v_exp_f32 v48, v48
    v_exp_f32 v49, v49
    v_exp_f32 v50, v50
    v_exp_f32 v51, v51
    v_exp_f32 v52, v52
    v_exp_f32 v53, v53
    v_exp_f32 v54, v54
    v_exp_f32 v55, v55
    v_cvt_pk_bf16_f32 v48, v48, v49
    v_cvt_pk_bf16_f32 v49, v50, v51
    v_cvt_pk_bf16_f32 v50, v52, v53
    v_cvt_pk_bf16_f32 v51, v54, v55
    v_mfma_f32_16x16x32_bf16 a[52:55], a[48:51], v[40:43], 0
    s_waitcnt lgkmcnt(8)
    v_exp_f32 v56, v56
    v_exp_f32 v57, v57
    v_exp_f32 v58, v58
    v_mfma_f32_16x16x32_bf16 v[168:171], a[0:3], v[40:43], 0
    s_waitcnt lgkmcnt(6)
    ds_read_b64_tr_b16 a[20:21], v25 offset:4096
    ds_read_b64_tr_b16 a[22:23], v25 offset:6144
    v_exp_f32 v59, v59
    v_exp_f32 v60, v60
    v_mfma_f32_16x16x32_bf16 v[172:175], a[4:7], v[40:43], 0
    s_waitcnt lgkmcnt(6)
    ds_read_b64_tr_b16 a[24:25], v26 offset:4096
    ds_read_b64_tr_b16 a[26:27], v26 offset:6144
    v_exp_f32 v61, v61
    v_exp_f32 v62, v62
    v_mfma_f32_16x16x32_bf16 v[176:179], a[8:11], v[40:43], 0
    s_waitcnt lgkmcnt(6)
    ds_read_b64_tr_b16 a[28:29], v27 offset:4096
    ds_read_b64_tr_b16 a[30:31], v27 offset:6144
    v_exp_f32 v63, v63
    v_cvt_pk_bf16_f32 v56, v56, v57
    v_mfma_f32_16x16x32_bf16 v[180:183], a[12:15], v[40:43], 0
    ds_read_b64_tr_b16 a[32:33], v24 offset:8192
    ds_read_b64_tr_b16 a[34:35], v24 offset:10240
    v_cvt_pk_bf16_f32 v57, v58, v59
    v_cvt_pk_bf16_f32 v58, v60, v61
    v_cvt_pk_bf16_f32 v59, v62, v63
    v_mfma_f32_16x16x32_bf16 a[52:55], a[48:51], v[48:51], a[52:55]
    s_waitcnt lgkmcnt(8)
    v_exp_f32 v64, v64
    v_exp_f32 v65, v65
    v_exp_f32 v66, v66
    v_mfma_f32_16x16x32_bf16 v[168:171], a[16:19], v[48:51], v[168:171]
    s_waitcnt lgkmcnt(6)
    ds_read_b64_tr_b16 a[36:37], v25 offset:8192
    ds_read_b64_tr_b16 a[38:39], v25 offset:10240
    v_exp_f32 v67, v67
    v_exp_f32 v68, v68
    v_mfma_f32_16x16x32_bf16 v[172:175], a[20:23], v[48:51], v[172:175]
    s_waitcnt lgkmcnt(6)
    ds_read_b64_tr_b16 a[40:41], v26 offset:8192
    ds_read_b64_tr_b16 a[42:43], v26 offset:10240
    v_exp_f32 v69, v69
    v_exp_f32 v70, v70
    v_mfma_f32_16x16x32_bf16 v[176:179], a[24:27], v[48:51], v[176:179]
    s_waitcnt lgkmcnt(6)
    ds_read_b64_tr_b16 a[44:45], v27 offset:8192
    ds_read_b64_tr_b16 a[46:47], v27 offset:10240
    v_exp_f32 v71, v71
    v_cvt_pk_bf16_f32 v64, v64, v65
    v_mfma_f32_16x16x32_bf16 v[180:183], a[28:31], v[48:51], v[180:183]
    ds_read_b64_tr_b16 a[0:1], v24 offset:12288
    ds_read_b64_tr_b16 a[2:3], v24 offset:14336
    v_cvt_pk_bf16_f32 v65, v66, v67
    v_cvt_pk_bf16_f32 v66, v68, v69
    v_cvt_pk_bf16_f32 v67, v70, v71
    v_mfma_f32_16x16x32_bf16 a[52:55], a[48:51], v[56:59], a[52:55]
    s_waitcnt lgkmcnt(8)
    v_exp_f32 v72, v72
    v_exp_f32 v73, v73
    v_exp_f32 v74, v74
    v_mfma_f32_16x16x32_bf16 v[168:171], a[32:35], v[56:59], v[168:171]
    s_waitcnt lgkmcnt(6)
    ds_read_b64_tr_b16 a[4:5], v25 offset:12288
    ds_read_b64_tr_b16 a[6:7], v25 offset:14336
    v_exp_f32 v75, v75
    v_exp_f32 v76, v76
    v_mfma_f32_16x16x32_bf16 v[172:175], a[36:39], v[56:59], v[172:175]
    s_waitcnt lgkmcnt(6)
    ds_read_b64_tr_b16 a[8:9], v26 offset:12288
    ds_read_b64_tr_b16 a[10:11], v26 offset:14336
    v_exp_f32 v77, v77
    v_exp_f32 v78, v78
    v_mfma_f32_16x16x32_bf16 v[176:179], a[40:43], v[56:59], v[176:179]
    s_waitcnt lgkmcnt(6)
    s_barrier
    ds_read_b64_tr_b16 a[12:13], v27 offset:12288
    ds_read_b64_tr_b16 a[14:15], v27 offset:14336
    v_exp_f32 v79, v79
    v_cvt_pk_bf16_f32 v72, v72, v73
    v_mfma_f32_16x16x32_bf16 v[180:183], a[44:47], v[56:59], v[180:183]
    ds_read_b64_tr_b16 a[16:17], v24 offset:16384
    ds_read_b64_tr_b16 a[18:19], v24 offset:18432
    v_cvt_pk_bf16_f32 v73, v74, v75
    v_cvt_pk_bf16_f32 v74, v76, v77
    v_cvt_pk_bf16_f32 v75, v78, v79
    v_mfma_f32_16x16x32_bf16 a[52:55], a[48:51], v[64:67], a[52:55]
    s_waitcnt lgkmcnt(8)
    v_exp_f32 v80, v80
    v_exp_f32 v81, v81
    v_exp_f32 v82, v82
    v_mfma_f32_16x16x32_bf16 v[168:171], a[0:3], v[64:67], v[168:171]
    s_waitcnt lgkmcnt(6)
    ds_read_b64_tr_b16 a[20:21], v25 offset:16384
    ds_read_b64_tr_b16 a[22:23], v25 offset:18432
    v_exp_f32 v83, v83
    v_exp_f32 v84, v84
    v_mfma_f32_16x16x32_bf16 v[172:175], a[4:7], v[64:67], v[172:175]
    s_waitcnt lgkmcnt(6)
    ds_read_b64_tr_b16 a[24:25], v26 offset:16384
    ds_read_b64_tr_b16 a[26:27], v26 offset:18432
    v_exp_f32 v85, v85
    v_exp_f32 v86, v86
    v_mfma_f32_16x16x32_bf16 v[176:179], a[8:11], v[64:67], v[176:179]
    s_waitcnt lgkmcnt(6)
    ds_read_b64_tr_b16 a[28:29], v27 offset:16384
    ds_read_b64_tr_b16 a[30:31], v27 offset:18432
    v_exp_f32 v87, v87
    v_cvt_pk_bf16_f32 v80, v80, v81
    v_mfma_f32_16x16x32_bf16 v[180:183], a[12:15], v[64:67], v[180:183]
    ds_read_b64_tr_b16 a[32:33], v24 offset:20480
    ds_read_b64_tr_b16 a[34:35], v24 offset:22528
    v_cvt_pk_bf16_f32 v81, v82, v83
    v_cvt_pk_bf16_f32 v82, v84, v85
    v_cvt_pk_bf16_f32 v83, v86, v87
    v_mfma_f32_16x16x32_bf16 a[52:55], a[48:51], v[72:75], a[52:55]
    s_waitcnt lgkmcnt(8)
    v_exp_f32 v88, v88
    v_exp_f32 v89, v89
    v_exp_f32 v90, v90
    v_mfma_f32_16x16x32_bf16 v[168:171], a[16:19], v[72:75], v[168:171]
    s_waitcnt lgkmcnt(6)
    ds_read_b64_tr_b16 a[36:37], v25 offset:20480
    ds_read_b64_tr_b16 a[38:39], v25 offset:22528
    v_exp_f32 v91, v91
    v_exp_f32 v92, v92
    v_mfma_f32_16x16x32_bf16 v[172:175], a[20:23], v[72:75], v[172:175]
    s_waitcnt lgkmcnt(6)
    ds_read_b64_tr_b16 a[40:41], v26 offset:20480
    ds_read_b64_tr_b16 a[42:43], v26 offset:22528
    v_exp_f32 v93, v93
    v_exp_f32 v94, v94
    v_mfma_f32_16x16x32_bf16 v[176:179], a[24:27], v[72:75], v[176:179]
    s_waitcnt lgkmcnt(6)
    ds_read_b64_tr_b16 a[44:45], v27 offset:20480
    ds_read_b64_tr_b16 a[46:47], v27 offset:22528
    v_exp_f32 v95, v95
    v_cvt_pk_bf16_f32 v88, v88, v89
    v_mfma_f32_16x16x32_bf16 v[180:183], a[28:31], v[72:75], v[180:183]
    ds_read_b64_tr_b16 a[0:1], v24 offset:24576
    ds_read_b64_tr_b16 a[2:3], v24 offset:26624
    v_cvt_pk_bf16_f32 v89, v90, v91
    v_cvt_pk_bf16_f32 v90, v92, v93
    v_cvt_pk_bf16_f32 v91, v94, v95
    v_mfma_f32_16x16x32_bf16 a[52:55], a[48:51], v[80:83], a[52:55]
    s_waitcnt lgkmcnt(8)
    v_exp_f32 v96, v96
    v_exp_f32 v97, v97
    v_exp_f32 v98, v98
    v_mfma_f32_16x16x32_bf16 v[168:171], a[32:35], v[80:83], v[168:171]
    s_waitcnt lgkmcnt(6)
    ds_read_b64_tr_b16 a[4:5], v25 offset:24576
    ds_read_b64_tr_b16 a[6:7], v25 offset:26624
    v_exp_f32 v99, v99
    v_exp_f32 v100, v100
    v_mfma_f32_16x16x32_bf16 v[172:175], a[36:39], v[80:83], v[172:175]
    s_waitcnt lgkmcnt(6)
    ds_read_b64_tr_b16 a[8:9], v26 offset:24576
    ds_read_b64_tr_b16 a[10:11], v26 offset:26624
    v_exp_f32 v101, v101
    v_exp_f32 v102, v102
    v_mfma_f32_16x16x32_bf16 v[176:179], a[40:43], v[80:83], v[176:179]
    s_waitcnt lgkmcnt(6)
    ds_read_b64_tr_b16 a[12:13], v27 offset:24576
    ds_read_b64_tr_b16 a[14:15], v27 offset:26624
    v_exp_f32 v103, v103
    v_cvt_pk_bf16_f32 v96, v96, v97
    v_mfma_f32_16x16x32_bf16 v[180:183], a[44:47], v[80:83], v[180:183]
    ds_read_b64_tr_b16 a[16:17], v24 offset:28672
    ds_read_b64_tr_b16 a[18:19], v24 offset:30720
    v_cvt_pk_bf16_f32 v97, v98, v99
    v_cvt_pk_bf16_f32 v98, v100, v101
    v_cvt_pk_bf16_f32 v99, v102, v103
    v_mfma_f32_16x16x32_bf16 a[52:55], a[48:51], v[88:91], a[52:55]
    s_waitcnt lgkmcnt(8)
    v_exp_f32 v104, v104
    v_exp_f32 v105, v105
    v_exp_f32 v106, v106
    v_mfma_f32_16x16x32_bf16 v[168:171], a[0:3], v[88:91], v[168:171]
    s_waitcnt lgkmcnt(6)
    ds_read_b64_tr_b16 a[20:21], v25 offset:28672
    ds_read_b64_tr_b16 a[22:23], v25 offset:30720
    v_exp_f32 v107, v107
    v_exp_f32 v108, v108
    v_mfma_f32_16x16x32_bf16 v[172:175], a[4:7], v[88:91], v[172:175]
    s_waitcnt lgkmcnt(6)
    ds_read_b64_tr_b16 a[24:25], v26 offset:28672
    ds_read_b64_tr_b16 a[26:27], v26 offset:30720
    v_exp_f32 v109, v109
    v_exp_f32 v110, v110
    v_mfma_f32_16x16x32_bf16 v[176:179], a[8:11], v[88:91], v[176:179]
    s_waitcnt lgkmcnt(6)
    s_barrier
    ds_read_b64_tr_b16 a[28:29], v27 offset:28672
    ds_read_b64_tr_b16 a[30:31], v27 offset:30720
    v_exp_f32 v111, v111
    v_cvt_pk_bf16_f32 v104, v104, v105
    v_mfma_f32_16x16x32_bf16 v[180:183], a[12:15], v[88:91], v[180:183]
    ds_read_b64_tr_b16 a[32:33], v24 offset:32768
    ds_read_b64_tr_b16 a[34:35], v24 offset:34816
    v_cvt_pk_bf16_f32 v105, v106, v107
    v_cvt_pk_bf16_f32 v106, v108, v109
    v_cvt_pk_bf16_f32 v107, v110, v111
    v_mfma_f32_16x16x32_bf16 a[52:55], a[48:51], v[96:99], a[52:55]
    s_waitcnt lgkmcnt(8)
    v_exp_f32 v112, v112
    v_exp_f32 v113, v113
    v_exp_f32 v114, v114
    v_mfma_f32_16x16x32_bf16 v[168:171], a[16:19], v[96:99], v[168:171]
    s_waitcnt lgkmcnt(6)
    ds_read_b64_tr_b16 a[36:37], v25 offset:32768
    ds_read_b64_tr_b16 a[38:39], v25 offset:34816
    v_exp_f32 v115, v115
    v_exp_f32 v116, v116
    v_mfma_f32_16x16x32_bf16 v[172:175], a[20:23], v[96:99], v[172:175]
    s_waitcnt lgkmcnt(6)
    ds_read_b64_tr_b16 a[40:41], v26 offset:32768
    ds_read_b64_tr_b16 a[42:43], v26 offset:34816
    v_exp_f32 v117, v117
    v_exp_f32 v118, v118
    v_mfma_f32_16x16x32_bf16 v[176:179], a[24:27], v[96:99], v[176:179]
    s_waitcnt lgkmcnt(6)
    ds_read_b64_tr_b16 a[44:45], v27 offset:32768
    ds_read_b64_tr_b16 a[46:47], v27 offset:34816
    v_exp_f32 v119, v119
    v_cvt_pk_bf16_f32 v112, v112, v113
    v_mfma_f32_16x16x32_bf16 v[180:183], a[28:31], v[96:99], v[180:183]
    ds_read_b64_tr_b16 a[0:1], v24 offset:36864
    ds_read_b64_tr_b16 a[2:3], v24 offset:38912
    v_cvt_pk_bf16_f32 v113, v114, v115
    v_cvt_pk_bf16_f32 v114, v116, v117
    v_cvt_pk_bf16_f32 v115, v118, v119
    v_mfma_f32_16x16x32_bf16 a[52:55], a[48:51], v[104:107], a[52:55]
    s_waitcnt lgkmcnt(8)
    v_exp_f32 v120, v120
    v_exp_f32 v121, v121
    v_exp_f32 v122, v122
    v_mfma_f32_16x16x32_bf16 v[168:171], a[32:35], v[104:107], v[168:171]
    s_waitcnt lgkmcnt(6)
    ds_read_b64_tr_b16 a[4:5], v25 offset:36864
    ds_read_b64_tr_b16 a[6:7], v25 offset:38912
    v_exp_f32 v123, v123
    v_exp_f32 v124, v124
    v_mfma_f32_16x16x32_bf16 v[172:175], a[36:39], v[104:107], v[172:175]
    s_waitcnt lgkmcnt(6)
    ds_read_b64_tr_b16 a[8:9], v26 offset:36864
    ds_read_b64_tr_b16 a[10:11], v26 offset:38912
    v_exp_f32 v125, v125
    v_exp_f32 v126, v126
    v_mfma_f32_16x16x32_bf16 v[176:179], a[40:43], v[104:107], v[176:179]
    s_waitcnt lgkmcnt(6)
    ds_read_b64_tr_b16 a[12:13], v27 offset:36864
    ds_read_b64_tr_b16 a[14:15], v27 offset:38912
    v_exp_f32 v127, v127
    v_cvt_pk_bf16_f32 v120, v120, v121
    v_mfma_f32_16x16x32_bf16 v[180:183], a[44:47], v[104:107], v[180:183]
    ds_read_b64_tr_b16 a[16:17], v24 offset:40960
    ds_read_b64_tr_b16 a[18:19], v24 offset:43008
    v_cvt_pk_bf16_f32 v121, v122, v123
    v_cvt_pk_bf16_f32 v122, v124, v125
    v_cvt_pk_bf16_f32 v123, v126, v127
    v_mfma_f32_16x16x32_bf16 a[52:55], a[48:51], v[112:115], a[52:55]
    s_waitcnt lgkmcnt(8)
    v_exp_f32 v128, v128
    v_exp_f32 v129, v129
    v_exp_f32 v130, v130
    v_mfma_f32_16x16x32_bf16 v[168:171], a[0:3], v[112:115], v[168:171]
    s_waitcnt lgkmcnt(6)
    ds_read_b64_tr_b16 a[20:21], v25 offset:40960
    ds_read_b64_tr_b16 a[22:23], v25 offset:43008
    v_exp_f32 v131, v131
    v_exp_f32 v132, v132
    v_mfma_f32_16x16x32_bf16 v[172:175], a[4:7], v[112:115], v[172:175]
    s_waitcnt lgkmcnt(6)
    ds_read_b64_tr_b16 a[24:25], v26 offset:40960
    ds_read_b64_tr_b16 a[26:27], v26 offset:43008
    v_exp_f32 v133, v133
    v_exp_f32 v134, v134
    v_mfma_f32_16x16x32_bf16 v[176:179], a[8:11], v[112:115], v[176:179]
    s_waitcnt lgkmcnt(6)
    ds_read_b64_tr_b16 a[28:29], v27 offset:40960
    ds_read_b64_tr_b16 a[30:31], v27 offset:43008
    v_exp_f32 v135, v135
    v_cvt_pk_bf16_f32 v128, v128, v129
    v_mfma_f32_16x16x32_bf16 v[180:183], a[12:15], v[112:115], v[180:183]
    ds_read_b64_tr_b16 a[32:33], v24 offset:45056
    ds_read_b64_tr_b16 a[34:35], v24 offset:47104
    v_cvt_pk_bf16_f32 v129, v130, v131
    v_cvt_pk_bf16_f32 v130, v132, v133
    v_cvt_pk_bf16_f32 v131, v134, v135
    v_mfma_f32_16x16x32_bf16 a[52:55], a[48:51], v[120:123], a[52:55]
    s_waitcnt lgkmcnt(8)
    v_exp_f32 v136, v136
    v_exp_f32 v137, v137
    v_exp_f32 v138, v138
    v_mfma_f32_16x16x32_bf16 v[168:171], a[16:19], v[120:123], v[168:171]
    s_waitcnt lgkmcnt(6)
    ds_read_b64_tr_b16 a[36:37], v25 offset:45056
    ds_read_b64_tr_b16 a[38:39], v25 offset:47104
    v_exp_f32 v139, v139
    v_exp_f32 v140, v140
    v_mfma_f32_16x16x32_bf16 v[172:175], a[20:23], v[120:123], v[172:175]
    s_waitcnt lgkmcnt(6)
    ds_read_b64_tr_b16 a[40:41], v26 offset:45056
    ds_read_b64_tr_b16 a[42:43], v26 offset:47104
    v_exp_f32 v141, v141
    v_exp_f32 v142, v142
    v_mfma_f32_16x16x32_bf16 v[176:179], a[24:27], v[120:123], v[176:179]
    s_waitcnt lgkmcnt(6)
    s_barrier
    ds_read_b64_tr_b16 a[44:45], v27 offset:45056
    ds_read_b64_tr_b16 a[46:47], v27 offset:47104
    v_exp_f32 v143, v143
    v_cvt_pk_bf16_f32 v136, v136, v137
    v_mfma_f32_16x16x32_bf16 v[180:183], a[28:31], v[120:123], v[180:183]
    ds_read_b64_tr_b16 a[0:1], v24 offset:49152
    ds_read_b64_tr_b16 a[2:3], v24 offset:51200
    v_cvt_pk_bf16_f32 v137, v138, v139
    v_cvt_pk_bf16_f32 v138, v140, v141
    v_cvt_pk_bf16_f32 v139, v142, v143
    v_mfma_f32_16x16x32_bf16 a[52:55], a[48:51], v[128:131], a[52:55]
    s_waitcnt lgkmcnt(8)
    v_exp_f32 v144, v144
    v_exp_f32 v145, v145
    v_exp_f32 v146, v146
    v_mfma_f32_16x16x32_bf16 v[168:171], a[32:35], v[128:131], v[168:171]
    s_waitcnt lgkmcnt(6)
    ds_read_b64_tr_b16 a[4:5], v25 offset:49152
    ds_read_b64_tr_b16 a[6:7], v25 offset:51200
    v_exp_f32 v147, v147
    v_exp_f32 v148, v148
    v_mfma_f32_16x16x32_bf16 v[172:175], a[36:39], v[128:131], v[172:175]
    s_waitcnt lgkmcnt(6)
    ds_read_b64_tr_b16 a[8:9], v26 offset:49152
    ds_read_b64_tr_b16 a[10:11], v26 offset:51200
    v_exp_f32 v149, v149
    v_exp_f32 v150, v150
    v_mfma_f32_16x16x32_bf16 v[176:179], a[40:43], v[128:131], v[176:179]
    s_waitcnt lgkmcnt(6)
    ds_read_b64_tr_b16 a[12:13], v27 offset:49152
    ds_read_b64_tr_b16 a[14:15], v27 offset:51200
    v_exp_f32 v151, v151
    v_cvt_pk_bf16_f32 v144, v144, v145
    v_mfma_f32_16x16x32_bf16 v[180:183], a[44:47], v[128:131], v[180:183]
    ds_read_b64_tr_b16 a[16:17], v24 offset:53248
    ds_read_b64_tr_b16 a[18:19], v24 offset:55296
    v_cvt_pk_bf16_f32 v145, v146, v147
    v_cvt_pk_bf16_f32 v146, v148, v149
    v_cvt_pk_bf16_f32 v147, v150, v151
    v_mfma_f32_16x16x32_bf16 a[52:55], a[48:51], v[136:139], a[52:55]
    s_waitcnt lgkmcnt(8)
    v_exp_f32 v152, v152
    v_exp_f32 v153, v153
    v_exp_f32 v154, v154
    v_mfma_f32_16x16x32_bf16 v[168:171], a[0:3], v[136:139], v[168:171]
    s_waitcnt lgkmcnt(6)
    ds_read_b64_tr_b16 a[20:21], v25 offset:53248
    ds_read_b64_tr_b16 a[22:23], v25 offset:55296
    v_exp_f32 v155, v155
    v_exp_f32 v156, v156
    v_mfma_f32_16x16x32_bf16 v[172:175], a[4:7], v[136:139], v[172:175]
    s_waitcnt lgkmcnt(6)
    ds_read_b64_tr_b16 a[24:25], v26 offset:53248
    ds_read_b64_tr_b16 a[26:27], v26 offset:55296
    v_exp_f32 v157, v157
    v_exp_f32 v158, v158
    v_mfma_f32_16x16x32_bf16 v[176:179], a[8:11], v[136:139], v[176:179]
    s_waitcnt lgkmcnt(6)
    ds_read_b64_tr_b16 a[28:29], v27 offset:53248
    ds_read_b64_tr_b16 a[30:31], v27 offset:55296
    v_exp_f32 v159, v159
    v_cvt_pk_bf16_f32 v152, v152, v153
    v_mfma_f32_16x16x32_bf16 v[180:183], a[12:15], v[136:139], v[180:183]
    ds_read_b64_tr_b16 a[32:33], v24 offset:57344
    ds_read_b64_tr_b16 a[34:35], v24 offset:59392
    v_cvt_pk_bf16_f32 v153, v154, v155
    v_cvt_pk_bf16_f32 v154, v156, v157
    v_cvt_pk_bf16_f32 v155, v158, v159
    v_mfma_f32_16x16x32_bf16 a[52:55], a[48:51], v[144:147], a[52:55]
    s_waitcnt lgkmcnt(8)
    v_exp_f32 v160, v160
    v_exp_f32 v161, v161
    v_exp_f32 v162, v162
    v_mfma_f32_16x16x32_bf16 v[168:171], a[16:19], v[144:147], v[168:171]
    s_waitcnt lgkmcnt(6)
    ds_read_b64_tr_b16 a[36:37], v25 offset:57344
    ds_read_b64_tr_b16 a[38:39], v25 offset:59392
    v_exp_f32 v163, v163
    v_exp_f32 v164, v164
    v_mfma_f32_16x16x32_bf16 v[172:175], a[20:23], v[144:147], v[172:175]
    s_waitcnt lgkmcnt(6)
    ds_read_b64_tr_b16 a[40:41], v26 offset:57344
    ds_read_b64_tr_b16 a[42:43], v26 offset:59392
    v_exp_f32 v165, v165
    v_exp_f32 v166, v166
    v_mfma_f32_16x16x32_bf16 v[176:179], a[24:27], v[144:147], v[176:179]
    s_waitcnt lgkmcnt(6)
    ds_read_b64_tr_b16 a[44:45], v27 offset:57344
    ds_read_b64_tr_b16 a[46:47], v27 offset:59392
    v_exp_f32 v167, v167
    v_cvt_pk_bf16_f32 v160, v160, v161
    v_mfma_f32_16x16x32_bf16 v[180:183], a[28:31], v[144:147], v[180:183]
    ds_read_b64_tr_b16 a[0:1], v24 offset:61440
    ds_read_b64_tr_b16 a[2:3], v24 offset:63488
    v_cvt_pk_bf16_f32 v161, v162, v163
    v_cvt_pk_bf16_f32 v162, v164, v165
    v_cvt_pk_bf16_f32 v163, v166, v167
    v_mfma_f32_16x16x32_bf16 a[52:55], a[48:51], v[152:155], a[52:55]
    s_waitcnt lgkmcnt(8)
    v_mfma_f32_16x16x32_bf16 v[168:171], a[32:35], v[152:155], v[168:171]
    s_waitcnt lgkmcnt(6)
    ds_read_b64_tr_b16 a[4:5], v25 offset:61440
    ds_read_b64_tr_b16 a[6:7], v25 offset:63488
    v_mfma_f32_16x16x32_bf16 v[172:175], a[36:39], v[152:155], v[172:175]
    s_waitcnt lgkmcnt(6)
    ds_read_b64_tr_b16 a[8:9], v26 offset:61440
    ds_read_b64_tr_b16 a[10:11], v26 offset:63488
    v_mfma_f32_16x16x32_bf16 v[176:179], a[40:43], v[152:155], v[176:179]
    s_waitcnt lgkmcnt(6)
    s_barrier
    ds_read_b64_tr_b16 a[12:13], v27 offset:61440
    ds_read_b64_tr_b16 a[14:15], v27 offset:63488
    v_mfma_f32_16x16x32_bf16 v[180:183], a[44:47], v[152:155], v[180:183]
    ds_read_b64_tr_b16 a[16:17], v28 offset:0
    ds_read_b64_tr_b16 a[18:19], v28 offset:2048
    v_mfma_f32_16x16x32_bf16 a[52:55], a[48:51], v[160:163], a[52:55]
    s_waitcnt lgkmcnt(8)
    v_mfma_f32_16x16x32_bf16 v[168:171], a[0:3], v[160:163], v[168:171]
    s_waitcnt lgkmcnt(6)
    ds_read_b64_tr_b16 a[20:21], v29 offset:0
    ds_read_b64_tr_b16 a[22:23], v29 offset:2048
    v_mfma_f32_16x16x32_bf16 v[172:175], a[4:7], v[160:163], v[172:175]
    s_waitcnt lgkmcnt(6)
    ds_read_b64_tr_b16 a[24:25], v30 offset:0
    ds_read_b64_tr_b16 a[26:27], v30 offset:2048
    v_accvgpr_read_b32 v36, a52
    v_mfma_f32_16x16x32_bf16 v[176:179], a[8:11], v[160:163], v[176:179]
    s_waitcnt lgkmcnt(6)
    ds_read_b64_tr_b16 a[28:29], v31 offset:0
    ds_read_b64_tr_b16 a[30:31], v31 offset:2048
    v_rcp_f32 v36, v36
    v_mfma_f32_16x16x32_bf16 v[180:183], a[12:15], v[160:163], v[180:183]
    s_waitcnt lgkmcnt(6)
    ds_read_b64_tr_b16 a[32:33], v28 offset:4096
    ds_read_b64_tr_b16 a[34:35], v28 offset:6144
    v_mul_f32 v168, v168, v36
    v_mul_f32 v169, v169, v36
    v_mul_f32 v170, v170, v36
    v_mfma_f32_16x16x32_bf16 v[184:187], a[16:19], v[40:43], 0
    s_waitcnt lgkmcnt(6)
    ds_read_b64_tr_b16 a[36:37], v29 offset:4096
    ds_read_b64_tr_b16 a[38:39], v29 offset:6144
    v_mul_f32 v171, v171, v36
    v_cvt_pk_bf16_f32 v108, v168, v169
    v_cvt_pk_bf16_f32 v109, v170, v171
    v_mfma_f32_16x16x32_bf16 v[188:191], a[20:23], v[40:43], 0
L_pg1:
    s_cbranch_execz L_pgr1
    s_waitcnt lgkmcnt(6)
    ds_read_b64_tr_b16 a[40:41], v30 offset:4096
    ds_read_b64_tr_b16 a[42:43], v30 offset:6144
    v_mul_f32 v172, v172, v36
    v_mul_f32 v173, v173, v36
    v_mul_f32 v174, v174, v36
    v_mfma_f32_16x16x32_bf16 v[192:195], a[24:27], v[40:43], 0
    s_waitcnt lgkmcnt(6)
    ds_read_b64_tr_b16 a[44:45], v31 offset:4096
    ds_read_b64_tr_b16 a[46:47], v31 offset:6144
    v_mul_f32 v175, v175, v36
    v_cvt_pk_bf16_f32 v110, v172, v173
    v_cvt_pk_bf16_f32 v111, v174, v175
    v_mfma_f32_16x16x32_bf16 v[196:199], a[28:31], v[40:43], 0
    s_waitcnt lgkmcnt(6)
    ds_read_b64_tr_b16 a[0:1], v28 offset:8192
    ds_read_b64_tr_b16 a[2:3], v28 offset:10240
    buffer_store_dwordx4 v[108:111], v2, s[40:43], s10 offen sc1
    v_mul_f32 v176, v176, v36
    v_mul_f32 v177, v177, v36
    v_mul_f32 v178, v178, v36
    v_mfma_f32_16x16x32_bf16 v[184:187], a[32:35], v[48:51], v[184:187]
    s_waitcnt lgkmcnt(6)
    ds_read_b64_tr_b16 a[4:5], v29 offset:8192
    ds_read_b64_tr_b16 a[6:7], v29 offset:10240
    v_mul_f32 v179, v179, v36
    v_cvt_pk_bf16_f32 v116, v176, v177
    v_cvt_pk_bf16_f32 v117, v178, v179
    v_mfma_f32_16x16x32_bf16 v[188:191], a[36:39], v[48:51], v[188:191]
    s_waitcnt lgkmcnt(6)
    ds_read_b64_tr_b16 a[8:9], v30 offset:8192
    ds_read_b64_tr_b16 a[10:11], v30 offset:10240
    v_mul_f32 v180, v180, v36
    v_mul_f32 v181, v181, v36
    v_mul_f32 v182, v182, v36
    v_mfma_f32_16x16x32_bf16 v[192:195], a[40:43], v[48:51], v[192:195]
    s_waitcnt lgkmcnt(6)
    ds_read_b64_tr_b16 a[12:13], v31 offset:8192
    ds_read_b64_tr_b16 a[14:15], v31 offset:10240
    v_mul_f32 v183, v183, v36
    v_cvt_pk_bf16_f32 v118, v180, v181
    v_cvt_pk_bf16_f32 v119, v182, v183
    v_mfma_f32_16x16x32_bf16 v[196:199], a[44:47], v[48:51], v[196:199]
    s_waitcnt lgkmcnt(6)
    ds_read_b64_tr_b16 a[16:17], v28 offset:12288
    ds_read_b64_tr_b16 a[18:19], v28 offset:14336
    buffer_store_dwordx4 v[116:119], v3, s[40:43], s10 offen sc1
    v_mfma_f32_16x16x32_bf16 v[184:187], a[0:3], v[56:59], v[184:187]
    s_waitcnt lgkmcnt(6)
    ds_read_b64_tr_b16 a[20:21], v29 offset:12288
    ds_read_b64_tr_b16 a[22:23], v29 offset:14336
    v_mov_b32 v37, v36
    v_mfma_f32_16x16x32_bf16 v[188:191], a[4:7], v[56:59], v[188:191]
    s_waitcnt lgkmcnt(6)
    ds_read_b64_tr_b16 a[24:25], v30 offset:12288
    ds_read_b64_tr_b16 a[26:27], v30 offset:14336
    v_mfma_f32_16x16x32_bf16 v[192:195], a[8:11], v[56:59], v[192:195]
    s_waitcnt lgkmcnt(6)
    s_barrier
    ds_read_b64_tr_b16 a[28:29], v31 offset:12288
    ds_read_b64_tr_b16 a[30:31], v31 offset:14336
    v_mfma_f32_16x16x32_bf16 v[196:199], a[12:15], v[56:59], v[196:199]
    s_waitcnt lgkmcnt(6)
    ds_read_b64_tr_b16 a[32:33], v28 offset:16384
    ds_read_b64_tr_b16 a[34:35], v28 offset:18432
    v_mfma_f32_16x16x32_bf16 v[184:187], a[16:19], v[64:67], v[184:187]
    s_waitcnt lgkmcnt(6)
    ds_read_b64_tr_b16 a[36:37], v29 offset:16384
    ds_read_b64_tr_b16 a[38:39], v29 offset:18432
    v_mfma_f32_16x16x32_bf16 v[188:191], a[20:23], v[64:67], v[188:191]
    s_waitcnt lgkmcnt(6)
    ds_read_b64_tr_b16 a[40:41], v30 offset:16384
    ds_read_b64_tr_b16 a[42:43], v30 offset:18432
    v_mfma_f32_16x16x32_bf16 v[192:195], a[24:27], v[64:67], v[192:195]
    s_waitcnt lgkmcnt(6)
    ds_read_b64_tr_b16 a[44:45], v31 offset:16384
    ds_read_b64_tr_b16 a[46:47], v31 offset:18432
    v_mfma_f32_16x16x32_bf16 v[196:199], a[28:31], v[64:67], v[196:199]
    s_waitcnt lgkmcnt(6)
    ds_read_b64_tr_b16 a[0:1], v28 offset:20480
    ds_read_b64_tr_b16 a[2:3], v28 offset:22528
    v_mfma_f32_16x16x32_bf16 v[184:187], a[32:35], v[72:75], v[184:187]
    s_waitcnt lgkmcnt(6)
    ds_read_b64_tr_b16 a[4:5], v29 offset:20480
    ds_read_b64_tr_b16 a[6:7], v29 offset:22528
    v_mfma_f32_16x16x32_bf16 v[188:191], a[36:39], v[72:75], v[188:191]
    s_waitcnt lgkmcnt(6)
    ds_read_b64_tr_b16 a[8:9], v30 offset:20480
    ds_read_b64_tr_b16 a[10:11], v30 offset:22528
    v_mfma_f32_16x16x32_bf16 v[192:195], a[40:43], v[72:75], v[192:195]
    s_waitcnt lgkmcnt(6)
    ds_read_b64_tr_b16 a[12:13], v31 offset:20480
    ds_read_b64_tr_b16 a[14:15], v31 offset:22528
    v_mfma_f32_16x16x32_bf16 v[196:199], a[44:47], v[72:75], v[196:199]
    s_waitcnt lgkmcnt(6)
    ds_read_b64_tr_b16 a[16:17], v28 offset:24576
    ds_read_b64_tr_b16 a[18:19], v28 offset:26624
    v_mfma_f32_16x16x32_bf16 v[184:187], a[0:3], v[80:83], v[184:187]
    s_waitcnt lgkmcnt(6)
    ds_read_b64_tr_b16 a[20:21], v29 offset:24576
    ds_read_b64_tr_b16 a[22:23], v29 offset:26624
    v_mfma_f32_16x16x32_bf16 v[188:191], a[4:7], v[80:83], v[188:191]
    s_waitcnt lgkmcnt(6)
    ds_read_b64_tr_b16 a[24:25], v30 offset:24576
    ds_read_b64_tr_b16 a[26:27], v30 offset:26624
    v_mfma_f32_16x16x32_bf16 v[192:195], a[8:11], v[80:83], v[192:195]
    s_waitcnt lgkmcnt(6)
    ds_read_b64_tr_b16 a[28:29], v31 offset:24576
    ds_read_b64_tr_b16 a[30:31], v31 offset:26624
    v_mfma_f32_16x16x32_bf16 v[196:199], a[12:15], v[80:83], v[196:199]
    s_waitcnt lgkmcnt(6)
    ds_read_b64_tr_b16 a[32:33], v28 offset:28672
    ds_read_b64_tr_b16 a[34:35], v28 offset:30720
    v_mfma_f32_16x16x32_bf16 v[184:187], a[16:19], v[88:91], v[184:187]
    s_waitcnt lgkmcnt(6)
    ds_read_b64_tr_b16 a[36:37], v29 offset:28672
    ds_read_b64_tr_b16 a[38:39], v29 offset:30720
    v_mfma_f32_16x16x32_bf16 v[188:191], a[20:23], v[88:91], v[188:191]
    s_waitcnt lgkmcnt(6)
    ds_read_b64_tr_b16 a[40:41], v30 offset:28672
    ds_read_b64_tr_b16 a[42:43], v30 offset:30720
    v_mfma_f32_16x16x32_bf16 v[192:195], a[24:27], v[88:91], v[192:195]
    s_waitcnt lgkmcnt(6)
    s_barrier
    ds_read_b64_tr_b16 a[44:45], v31 offset:28672
    ds_read_b64_tr_b16 a[46:47], v31 offset:30720
    v_mfma_f32_16x16x32_bf16 v[196:199], a[28:31], v[88:91], v[196:199]
    s_waitcnt lgkmcnt(6)
    ds_read_b64_tr_b16 a[0:1], v28 offset:32768
    ds_read_b64_tr_b16 a[2:3], v28 offset:34816
    v_mfma_f32_16x16x32_bf16 v[184:187], a[32:35], v[96:99], v[184:187]
    s_waitcnt lgkmcnt(6)
    ds_read_b64_tr_b16 a[4:5], v29 offset:32768
    ds_read_b64_tr_b16 a[6:7], v29 offset:34816
    v_mfma_f32_16x16x32_bf16 v[188:191], a[36:39], v[96:99], v[188:191]
    s_waitcnt lgkmcnt(6)
    ds_read_b64_tr_b16 a[8:9], v30 offset:32768
    ds_read_b64_tr_b16 a[10:11], v30 offset:34816
    v_mfma_f32_16x16x32_bf16 v[192:195], a[40:43], v[96:99], v[192:195]
    s_waitcnt lgkmcnt(6)
    ds_read_b64_tr_b16 a[12:13], v31 offset:32768
    ds_read_b64_tr_b16 a[14:15], v31 offset:34816
    v_mfma_f32_16x16x32_bf16 v[196:199], a[44:47], v[96:99], v[196:199]
    s_waitcnt lgkmcnt(6)
    ds_read_b64_tr_b16 a[16:17], v28 offset:36864
    ds_read_b64_tr_b16 a[18:19], v28 offset:38912
    v_mfma_f32_16x16x32_bf16 v[184:187], a[0:3], v[104:107], v[184:187]
    s_waitcnt lgkmcnt(6)
    ds_read_b64_tr_b16 a[20:21], v29 offset:36864
    ds_read_b64_tr_b16 a[22:23], v29 offset:38912
    v_mfma_f32_16x16x32_bf16 v[188:191], a[4:7], v[104:107], v[188:191]
    s_waitcnt lgkmcnt(6)
    ds_read_b64_tr_b16 a[24:25], v30 offset:36864
    ds_read_b64_tr_b16 a[26:27], v30 offset:38912
    v_mfma_f32_16x16x32_bf16 v[192:195], a[8:11], v[104:107], v[192:195]
    s_waitcnt lgkmcnt(6)
    ds_read_b64_tr_b16 a[28:29], v31 offset:36864
    ds_read_b64_tr_b16 a[30:31], v31 offset:38912
    v_mfma_f32_16x16x32_bf16 v[196:199], a[12:15], v[104:107], v[196:199]
    s_waitcnt lgkmcnt(6)
    ds_read_b64_tr_b16 a[32:33], v28 offset:40960
    ds_read_b64_tr_b16 a[34:35], v28 offset:43008
    v_mfma_f32_16x16x32_bf16 v[184:187], a[16:19], v[112:115], v[184:187]
    s_waitcnt lgkmcnt(6)
    ds_read_b64_tr_b16 a[36:37], v29 offset:40960
    ds_read_b64_tr_b16 a[38:39], v29 offset:43008
    v_mfma_f32_16x16x32_bf16 v[188:191], a[20:23], v[112:115], v[188:191]
    s_waitcnt lgkmcnt(6)
    ds_read_b64_tr_b16 a[40:41], v30 offset:40960
    ds_read_b64_tr_b16 a[42:43], v30 offset:43008
    v_mfma_f32_16x16x32_bf16 v[192:195], a[24:27], v[112:115], v[192:195]
    s_waitcnt lgkmcnt(6)
    ds_read_b64_tr_b16 a[44:45], v31 offset:40960
    ds_read_b64_tr_b16 a[46:47], v31 offset:43008
    v_mfma_f32_16x16x32_bf16 v[196:199], a[28:31], v[112:115], v[196:199]
    s_waitcnt lgkmcnt(6)
    ds_read_b64_tr_b16 a[0:1], v28 offset:45056
    ds_read_b64_tr_b16 a[2:3], v28 offset:47104
    v_mfma_f32_16x16x32_bf16 v[184:187], a[32:35], v[120:123], v[184:187]
    s_waitcnt lgkmcnt(6)
    ds_read_b64_tr_b16 a[4:5], v29 offset:45056
    ds_read_b64_tr_b16 a[6:7], v29 offset:47104
    v_mfma_f32_16x16x32_bf16 v[188:191], a[36:39], v[120:123], v[188:191]
    s_waitcnt lgkmcnt(6)
    ds_read_b64_tr_b16 a[8:9], v30 offset:45056
    ds_read_b64_tr_b16 a[10:11], v30 offset:47104
    v_mfma_f32_16x16x32_bf16 v[192:195], a[40:43], v[120:123], v[192:195]
    s_waitcnt lgkmcnt(6)
    s_barrier
    ds_read_b64_tr_b16 a[12:13], v31 offset:45056
    ds_read_b64_tr_b16 a[14:15], v31 offset:47104
    v_mfma_f32_16x16x32_bf16 v[196:199], a[44:47], v[120:123], v[196:199]
    s_waitcnt lgkmcnt(6)
    ds_read_b64_tr_b16 a[16:17], v28 offset:49152
    ds_read_b64_tr_b16 a[18:19], v28 offset:51200
    v_mfma_f32_16x16x32_bf16 v[184:187], a[0:3], v[128:131], v[184:187]
    s_waitcnt lgkmcnt(6)
    ds_read_b64_tr_b16 a[20:21], v29 offset:49152
    ds_read_b64_tr_b16 a[22:23], v29 offset:51200
    v_mfma_f32_16x16x32_bf16 v[188:191], a[4:7], v[128:131], v[188:191]
    s_waitcnt lgkmcnt(6)
    ds_read_b64_tr_b16 a[24:25], v30 offset:49152
    ds_read_b64_tr_b16 a[26:27], v30 offset:51200
    v_mfma_f32_16x16x32_bf16 v[192:195], a[8:11], v[128:131], v[192:195]
    s_waitcnt lgkmcnt(6)
    ds_read_b64_tr_b16 a[28:29], v31 offset:49152
    ds_read_b64_tr_b16 a[30:31], v31 offset:51200
    v_mfma_f32_16x16x32_bf16 v[196:199], a[12:15], v[128:131], v[196:199]
    s_waitcnt lgkmcnt(6)
    ds_read_b64_tr_b16 a[32:33], v28 offset:53248
    ds_read_b64_tr_b16 a[34:35], v28 offset:55296
    v_mfma_f32_16x16x32_bf16 v[184:187], a[16:19], v[136:139], v[184:187]
    s_waitcnt lgkmcnt(6)
    ds_read_b64_tr_b16 a[36:37], v29 offset:53248
    ds_read_b64_tr_b16 a[38:39], v29 offset:55296
    v_mfma_f32_16x16x32_bf16 v[188:191], a[20:23], v[136:139], v[188:191]
    s_waitcnt lgkmcnt(6)
    ds_read_b64_tr_b16 a[40:41], v30 offset:53248
    ds_read_b64_tr_b16 a[42:43], v30 offset:55296
    v_mfma_f32_16x16x32_bf16 v[192:195], a[24:27], v[136:139], v[192:195]
    s_waitcnt lgkmcnt(6)
    ds_read_b64_tr_b16 a[44:45], v31 offset:53248
    ds_read_b64_tr_b16 a[46:47], v31 offset:55296
    v_mfma_f32_16x16x32_bf16 v[196:199], a[28:31], v[136:139], v[196:199]
    s_waitcnt lgkmcnt(6)
    ds_read_b64_tr_b16 a[0:1], v28 offset:57344
    ds_read_b64_tr_b16 a[2:3], v28 offset:59392
    v_mfma_f32_16x16x32_bf16 v[184:187], a[32:35], v[144:147], v[184:187]
    s_waitcnt lgkmcnt(6)
    ds_read_b64_tr_b16 a[4:5], v29 offset:57344
    ds_read_b64_tr_b16 a[6:7], v29 offset:59392
    v_mfma_f32_16x16x32_bf16 v[188:191], a[36:39], v[144:147], v[188:191]
    s_waitcnt lgkmcnt(6)
    ds_read_b64_tr_b16 a[8:9], v30 offset:57344
    ds_read_b64_tr_b16 a[10:11], v30 offset:59392
    v_mfma_f32_16x16x32_bf16 v[192:195], a[40:43], v[144:147], v[192:195]
    s_waitcnt lgkmcnt(6)
    ds_read_b64_tr_b16 a[12:13], v31 offset:57344
    ds_read_b64_tr_b16 a[14:15], v31 offset:59392
    v_mfma_f32_16x16x32_bf16 v[196:199], a[44:47], v[144:147], v[196:199]
    s_waitcnt lgkmcnt(6)
    ds_read_b64_tr_b16 a[16:17], v28 offset:61440
    ds_read_b64_tr_b16 a[18:19], v28 offset:63488
    v_mfma_f32_16x16x32_bf16 v[184:187], a[0:3], v[152:155], v[184:187]
    s_waitcnt lgkmcnt(6)
    ds_read_b64_tr_b16 a[20:21], v29 offset:61440
    ds_read_b64_tr_b16 a[22:23], v29 offset:63488
    v_mfma_f32_16x16x32_bf16 v[188:191], a[4:7], v[152:155], v[188:191]
    s_waitcnt lgkmcnt(6)
    ds_read_b64_tr_b16 a[24:25], v30 offset:61440
    ds_read_b64_tr_b16 a[26:27], v30 offset:63488
    v_mfma_f32_16x16x32_bf16 v[192:195], a[8:11], v[152:155], v[192:195]
    s_waitcnt lgkmcnt(6)
    ds_read_b64_tr_b16 a[28:29], v31 offset:61440
    ds_read_b64_tr_b16 a[30:31], v31 offset:63488
    v_mfma_f32_16x16x32_bf16 v[196:199], a[12:15], v[152:155], v[196:199]
    s_waitcnt lgkmcnt(6)
    v_mfma_f32_16x16x32_bf16 v[184:187], a[16:19], v[160:163], v[184:187]
    s_waitcnt lgkmcnt(4)
    v_mfma_f32_16x16x32_bf16 v[188:191], a[20:23], v[160:163], v[188:191]
    s_waitcnt lgkmcnt(2)
    v_mfma_f32_16x16x32_bf16 v[192:195], a[24:27], v[160:163], v[192:195]
    s_waitcnt lgkmcnt(0)
    v_mfma_f32_16x16x32_bf16 v[196:199], a[28:31], v[160:163], v[196:199]
    s_nop 1
    v_mul_f32 v184, v184, v36
    v_mul_f32 v185, v185, v36
    v_mul_f32 v186, v186, v36
    v_mul_f32 v187, v187, v36
    v_cvt_pk_bf16_f32 v124, v184, v185
    v_cvt_pk_bf16_f32 v125, v186, v187
    v_mul_f32 v188, v188, v36
    v_mul_f32 v189, v189, v36
    v_mul_f32 v190, v190, v36
    v_mul_f32 v191, v191, v36
    v_cvt_pk_bf16_f32 v126, v188, v189
    v_cvt_pk_bf16_f32 v127, v190, v191
    buffer_store_dwordx4 v[124:127], v2, s[40:43], s28 offen sc1
    v_pk_mul_f32 v[192:193], v[192:193], v[36:37]
    v_pk_mul_f32 v[194:195], v[194:195], v[36:37]
    v_cvt_pk_bf16_f32 v132, v192, v193
    v_cvt_pk_bf16_f32 v133, v194, v195
    v_pk_mul_f32 v[196:197], v[196:197], v[36:37]
    v_pk_mul_f32 v[198:199], v[198:199], v[36:37]
    v_cvt_pk_bf16_f32 v134, v196, v197
    v_cvt_pk_bf16_f32 v135, v198, v199
    buffer_store_dwordx4 v[132:135], v3, s[40:43], s28 offen sc1
L_attn_done:
    s_barrier
    v_lshrrev_b32 v12, 1, v10
    v_lshl_add_u32 v12, v4, 1, v12
    s_lshl_b32 s60, s64, 1
    v_xor_b32 v12, s60, v12
    v_and_b32 v12, 3, v12
    v_lshl_add_u32 v12, v12, 5, v11
    v_lshl_add_u32 v13, v4, 2, v10
    v_lshl_add_u32 v12, v13, 7, v12
    s_lshl_b32 s60, s64, 3
    s_add_u32 s60, s60, s59
    s_lshl_b32 s60, s60, 12
    v_add_u32 v16, s60, v12
    v_xor_b32 v20, 4096, v16
    v_xor_b32 v17, 32, v16
    v_xor_b32 v21, 32, v20
    v_xor_b32 v18, 64, v16
    v_xor_b32 v22, 64, v20
    v_xor_b32 v19, 96, v16
    v_xor_b32 v23, 96, v20
    v_mov_b32 v35, s55
    v_mov_b32 v39, s55
    v_mov_b32 v43, s55
    v_mov_b32 v47, s55
    s_lshl_b32 s60, s52, 2
    s_add_u32 s60, s60, 155648
    v_add_u32 v29, s60, v2
    s_mul_i32 s60, s52, 6144
    s_add_u32 s60, s60, 131072
    v_add_u32 v24, s60, v2
    s_xor_b32 s60, s52, 1
    s_mul_i32 s60, s60, 6144
    s_add_u32 s60, s60, 131072
    v_add_u32 v25, s60, v2
    s_barrier
    buffer_load_dwordx4 v[48:51], v5, s[40:43], s12 offen offset:0 sc1
    buffer_load_dwordx4 v[52:55], v5, s[40:43], s12 offen offset:1024 sc1
    buffer_load_dwordx4 v[56:59], v5, s[40:43], s12 offen offset:2048 sc1
    buffer_load_dwordx4 v[60:63], v6, s[40:43], s12 offen offset:0 sc1
    buffer_load_dwordx4 v[64:67], v6, s[40:43], s12 offen offset:1024 sc1
    buffer_load_dwordx4 v[68:71], v6, s[40:43], s12 offen offset:2048 sc1
    buffer_load_dwordx4 v[72:75], v5, s[40:43], s13 offen offset:0 sc1
    buffer_load_dwordx4 v[76:79], v5, s[40:43], s13 offen offset:1024 sc1
    buffer_load_dwordx4 v[80:83], v5, s[40:43], s13 offen offset:2048 sc1
    buffer_load_dwordx4 v[84:87], v6, s[40:43], s13 offen offset:0 sc1
    buffer_load_dwordx4 v[88:91], v6, s[40:43], s13 offen offset:1024 sc1
    buffer_load_dwordx4 v[92:95], v6, s[40:43], s13 offen offset:2048 sc1
    s_barrier
    ds_read_b64_tr_b16 a[8:9], v18 offset:0
    ds_read_b64_tr_b16 a[10:11], v18 offset:2048
    ds_read_b64_tr_b16 a[12:13], v19 offset:0
    ds_read_b64_tr_b16 a[14:15], v19 offset:2048
    ds_read_b64_tr_b16 a[0:1], v16 offset:0
    ds_read_b64_tr_b16 a[2:3], v16 offset:2048
    ds_read_b64_tr_b16 a[4:5], v17 offset:0
    ds_read_b64_tr_b16 a[6:7], v17 offset:2048
    s_waitcnt vmcnt(9)
    v_fma_f32 v8, v51, v55, v59
    v_cmp_u_f32 vcc, v8, v8
    s_cbranch_vccnz L_o0_slow
L_o0_ok:
    s_waitcnt lgkmcnt(6)
    v_mfma_f32_16x16x32_bf16 v[168:171], v[48:51], a[8:11], 0
    s_waitcnt lgkmcnt(4)
    ds_read_b64_tr_b16 a[24:25], v22 offset:0
    v_xor_b32 v18, 8192, v18
    v_mfma_f32_16x16x32_bf16 v[180:183], v[48:51], a[12:15], 0
    s_waitcnt lgkmcnt(3)
    ds_read_b64_tr_b16 a[26:27], v22 offset:2048
    v_xor_b32 v19, 8192, v19
    v_mfma_f32_16x16x32_bf16 v[144:147], v[48:51], a[0:3], 0
    s_waitcnt lgkmcnt(2)
    buffer_load_dwordx4 v[96:99], v5, s[40:43], s14 offen offset:0 sc1
    v_mfma_f32_16x16x32_bf16 v[156:159], v[48:51], a[4:7], 0
    ds_read_b64_tr_b16 a[28:29], v23 offset:0
    v_xor_b32 v16, 8192, v16
    v_mfma_f32_16x16x32_bf16 v[172:175], v[52:55], a[8:11], 0
    ds_read_b64_tr_b16 a[30:31], v23 offset:2048
    v_xor_b32 v17, 8192, v17
    v_mfma_f32_16x16x32_bf16 v[184:187], v[52:55], a[12:15], 0
    ds_read_b64_tr_b16 a[16:17], v20 offset:0
    v_mfma_f32_16x16x32_bf16 v[148:151], v[52:55], a[0:3], 0
    buffer_load_dwordx4 v[100:103], v5, s[40:43], s14 offen offset:1024 sc1
    v_mfma_f32_16x16x32_bf16 v[160:163], v[52:55], a[4:7], 0
    ds_read_b64_tr_b16 a[18:19], v20 offset:2048
    v_mfma_f32_16x16x32_bf16 v[176:179], v[56:59], a[8:11], 0
    ds_read_b64_tr_b16 a[20:21], v21 offset:0
    v_mfma_f32_16x16x32_bf16 v[188:191], v[56:59], a[12:15], 0
    s_waitcnt vmcnt(8)
    ds_read_b64_tr_b16 a[22:23], v21 offset:2048
    v_fma_f32 v8, v63, v67, v71
    v_cmp_u_f32 vcc, v8, v8
    v_mfma_f32_16x16x32_bf16 v[152:155], v[56:59], a[0:3], 0
    buffer_load_dwordx4 v[104:107], v5, s[40:43], s14 offen offset:2048 sc1
    v_mfma_f32_16x16x32_bf16 v[164:167], v[56:59], a[4:7], 0
    s_waitcnt lgkmcnt(6)
    s_cbranch_vccnz L_o1_slow
L_o1_ok:
    v_mfma_f32_16x16x32_bf16 v[168:171], v[60:63], a[24:27], v[168:171]
    s_waitcnt lgkmcnt(4)
    ds_read_b64_tr_b16 a[40:41], v18 offset:0
    v_xor_b32 v22, 8192, v22
    v_mfma_f32_16x16x32_bf16 v[180:183], v[60:63], a[28:31], v[180:183]
    s_waitcnt lgkmcnt(3)
    ds_read_b64_tr_b16 a[42:43], v18 offset:2048
    v_xor_b32 v23, 8192, v23
    v_mfma_f32_16x16x32_bf16 v[144:147], v[60:63], a[16:19], v[144:147]
    s_waitcnt lgkmcnt(2)
    buffer_load_dwordx4 v[108:111], v6, s[40:43], s14 offen offset:0 sc1
    v_mfma_f32_16x16x32_bf16 v[156:159], v[60:63], a[20:23], v[156:159]
    ds_read_b64_tr_b16 a[44:45], v19 offset:0
    v_xor_b32 v20, 8192, v20
    v_mfma_f32_16x16x32_bf16 v[172:175], v[64:67], a[24:27], v[172:175]
    ds_read_b64_tr_b16 a[46:47], v19 offset:2048
    v_xor_b32 v21, 8192, v21
    v_mfma_f32_16x16x32_bf16 v[184:187], v[64:67], a[28:31], v[184:187]
    ds_read_b64_tr_b16 a[32:33], v16 offset:0
    v_mfma_f32_16x16x32_bf16 v[148:151], v[64:67], a[16:19], v[148:151]
    buffer_load_dwordx4 v[112:115], v6, s[40:43], s14 offen offset:1024 sc1
    v_mfma_f32_16x16x32_bf16 v[160:163], v[64:67], a[20:23], v[160:163]
    ds_read_b64_tr_b16 a[34:35], v16 offset:2048
    v_mfma_f32_16x16x32_bf16 v[176:179], v[68:71], a[24:27], v[176:179]
    ds_read_b64_tr_b16 a[36:37], v17 offset:0
    v_mfma_f32_16x16x32_bf16 v[188:191], v[68:71], a[28:31], v[188:191]
    s_waitcnt vmcnt(8)
    ds_read_b64_tr_b16 a[38:39], v17 offset:2048
    v_fma_f32 v8, v75, v79, v83
    v_cmp_u_f32 vcc, v8, v8
    v_mfma_f32_16x16x32_bf16 v[152:155], v[68:71], a[16:19], v[152:155]
    buffer_load_dwordx4 v[116:119], v6, s[40:43], s14 offen offset:2048 sc1
    v_mfma_f32_16x16x32_bf16 v[164:167], v[68:71], a[20:23], v[164:167]
    s_waitcnt lgkmcnt(6)
    s_cbranch_vccnz L_o2_slow
L_o2_ok:
    v_mfma_f32_16x16x32_bf16 v[168:171], v[72:75], a[40:43], v[168:171]
    s_waitcnt lgkmcnt(4)
    ds_read_b64_tr_b16 a[8:9], v22 offset:0
    v_xor_b32 v18, 24576, v18
    v_mfma_f32_16x16x32_bf16 v[180:183], v[72:75], a[44:47], v[180:183]
    s_waitcnt lgkmcnt(3)
    ds_read_b64_tr_b16 a[10:11], v22 offset:2048
    v_xor_b32 v19, 24576, v19
    v_mfma_f32_16x16x32_bf16 v[144:147], v[72:75], a[32:35], v[144:147]
    s_waitcnt lgkmcnt(2)
    buffer_load_dwordx4 v[120:123], v5, s[40:43], s15 offen offset:0 sc1
    v_mfma_f32_16x16x32_bf16 v[156:159], v[72:75], a[36:39], v[156:159]
    ds_read_b64_tr_b16 a[12:13], v23 offset:0
    v_xor_b32 v16, 24576, v16
    v_mfma_f32_16x16x32_bf16 v[172:175], v[76:79], a[40:43], v[172:175]
    ds_read_b64_tr_b16 a[14:15], v23 offset:2048
    v_xor_b32 v17, 24576, v17
    v_mfma_f32_16x16x32_bf16 v[184:187], v[76:79], a[44:47], v[184:187]
    ds_read_b64_tr_b16 a[0:1], v20 offset:0
    v_mfma_f32_16x16x32_bf16 v[148:151], v[76:79], a[32:35], v[148:151]
    buffer_load_dwordx4 v[124:127], v5, s[40:43], s15 offen offset:1024 sc1
    v_mfma_f32_16x16x32_bf16 v[160:163], v[76:79], a[36:39], v[160:163]
    ds_read_b64_tr_b16 a[2:3], v20 offset:2048
    v_mfma_f32_16x16x32_bf16 v[176:179], v[80:83], a[40:43], v[176:179]
    ds_read_b64_tr_b16 a[4:5], v21 offset:0
    v_mfma_f32_16x16x32_bf16 v[188:191], v[80:83], a[44:47], v[188:191]
    s_waitcnt vmcnt(8)
    ds_read_b64_tr_b16 a[6:7], v21 offset:2048
    v_fma_f32 v8, v87, v91, v95
    v_cmp_u_f32 vcc, v8, v8
    v_mfma_f32_16x16x32_bf16 v[152:155], v[80:83], a[32:35], v[152:155]
    buffer_load_dwordx4 v[128:131], v5, s[40:43], s15 offen offset:2048 sc1
    v_mfma_f32_16x16x32_bf16 v[164:167], v[80:83], a[36:39], v[164:167]
    s_waitcnt lgkmcnt(6)
    s_cbranch_vccnz L_o3_slow
L_o3_ok:
    v_mfma_f32_16x16x32_bf16 v[168:171], v[84:87], a[8:11], v[168:171]
    s_waitcnt lgkmcnt(4)
    ds_read_b64_tr_b16 a[24:25], v18 offset:0
    v_xor_b32 v22, 24576, v22
    v_mfma_f32_16x16x32_bf16 v[180:183], v[84:87], a[12:15], v[180:183]
    s_waitcnt lgkmcnt(3)
    ds_read_b64_tr_b16 a[26:27], v18 offset:2048
    v_xor_b32 v23, 24576, v23
    v_mfma_f32_16x16x32_bf16 v[144:147], v[84:87], a[0:3], v[144:147]
    s_waitcnt lgkmcnt(2)
    buffer_load_dwordx4 v[132:135], v6, s[40:43], s15 offen offset:0 sc1
    v_mfma_f32_16x16x32_bf16 v[156:159], v[84:87], a[4:7], v[156:159]
    ds_read_b64_tr_b16 a[28:29], v19 offset:0
    v_xor_b32 v20, 24576, v20
    v_mfma_f32_16x16x32_bf16 v[172:175], v[88:91], a[8:11], v[172:175]
    ds_read_b64_tr_b16 a[30:31], v19 offset:2048
    v_xor_b32 v21, 24576, v21
    v_mfma_f32_16x16x32_bf16 v[184:187], v[88:91], a[12:15], v[184:187]
    ds_read_b64_tr_b16 a[16:17], v16 offset:0
    v_mfma_f32_16x16x32_bf16 v[148:151], v[88:91], a[0:3], v[148:151]
    buffer_load_dwordx4 v[136:139], v6, s[40:43], s15 offen offset:1024 sc1
    v_mfma_f32_16x16x32_bf16 v[160:163], v[88:91], a[4:7], v[160:163]
    ds_read_b64_tr_b16 a[18:19], v16 offset:2048
    v_mfma_f32_16x16x32_bf16 v[176:179], v[92:95], a[8:11], v[176:179]
    ds_read_b64_tr_b16 a[20:21], v17 offset:0
    v_mfma_f32_16x16x32_bf16 v[188:191], v[92:95], a[12:15], v[188:191]
    s_waitcnt vmcnt(8)
    ds_read_b64_tr_b16 a[22:23], v17 offset:2048
    v_fma_f32 v8, v99, v103, v107
    v_cmp_u_f32 vcc, v8, v8
    v_mfma_f32_16x16x32_bf16 v[152:155], v[92:95], a[0:3], v[152:155]
    buffer_load_dwordx4 v[140:143], v6, s[40:43], s15 offen offset:2048 sc1
    v_mfma_f32_16x16x32_bf16 v[164:167], v[92:95], a[4:7], v[164:167]
    s_waitcnt lgkmcnt(6)
    s_cbranch_vccnz L_o4_slow
L_o4_ok:
    v_mfma_f32_16x16x32_bf16 v[168:171], v[96:99], a[24:27], v[168:171]
    s_waitcnt lgkmcnt(4)
    ds_read_b64_tr_b16 a[40:41], v22 offset:0
    v_xor_b32 v18, 8192, v18
    v_mfma_f32_16x16x32_bf16 v[180:183], v[96:99], a[28:31], v[180:183]
    s_waitcnt lgkmcnt(3)
    ds_read_b64_tr_b16 a[42:43], v22 offset:2048
    v_xor_b32 v19, 8192, v19
    v_mfma_f32_16x16x32_bf16 v[144:147], v[96:99], a[16:19], v[144:147]
    s_waitcnt lgkmcnt(2)
    buffer_load_dwordx4 v[48:51], v5, s[40:43], s16 offen offset:0 sc1
    v_mfma_f32_16x16x32_bf16 v[156:159], v[96:99], a[20:23], v[156:159]
    ds_read_b64_tr_b16 a[44:45], v23 offset:0
    v_xor_b32 v16, 8192, v16
    v_mfma_f32_16x16x32_bf16 v[172:175], v[100:103], a[24:27], v[172:175]
    ds_read_b64_tr_b16 a[46:47], v23 offset:2048
    v_xor_b32 v17, 8192, v17
    v_mfma_f32_16x16x32_bf16 v[184:187], v[100:103], a[28:31], v[184:187]
    ds_read_b64_tr_b16 a[32:33], v20 offset:0
    v_mfma_f32_16x16x32_bf16 v[148:151], v[100:103], a[16:19], v[148:151]
    buffer_load_dwordx4 v[52:55], v5, s[40:43], s16 offen offset:1024 sc1
    v_mfma_f32_16x16x32_bf16 v[160:163], v[100:103], a[20:23], v[160:163]
    ds_read_b64_tr_b16 a[34:35], v20 offset:2048
    v_mfma_f32_16x16x32_bf16 v[176:179], v[104:107], a[24:27], v[176:179]
    ds_read_b64_tr_b16 a[36:37], v21 offset:0
    v_mfma_f32_16x16x32_bf16 v[188:191], v[104:107], a[28:31], v[188:191]
    s_waitcnt vmcnt(8)
    ds_read_b64_tr_b16 a[38:39], v21 offset:2048
    v_fma_f32 v8, v111, v115, v119
    v_cmp_u_f32 vcc, v8, v8
    v_mfma_f32_16x16x32_bf16 v[152:155], v[104:107], a[16:19], v[152:155]
    buffer_load_dwordx4 v[56:59], v5, s[40:43], s16 offen offset:2048 sc1
    v_mfma_f32_16x16x32_bf16 v[164:167], v[104:107], a[20:23], v[164:167]
    s_waitcnt lgkmcnt(6)
    s_cbranch_vccnz L_o5_slow
L_o5_ok:
    v_mfma_f32_16x16x32_bf16 v[168:171], v[108:111], a[40:43], v[168:171]
    s_waitcnt lgkmcnt(4)
    ds_read_b64_tr_b16 a[8:9], v18 offset:0
    v_xor_b32 v22, 8192, v22
    v_mfma_f32_16x16x32_bf16 v[180:183], v[108:111], a[44:47], v[180:183]
    s_waitcnt lgkmcnt(3)
    ds_read_b64_tr_b16 a[10:11], v18 offset:2048
    v_xor_b32 v23, 8192, v23
    v_mfma_f32_16x16x32_bf16 v[144:147], v[108:111], a[32:35], v[144:147]
    s_waitcnt lgkmcnt(2)
    buffer_load_dwordx4 v[60:63], v6, s[40:43], s16 offen offset:0 sc1
    v_mfma_f32_16x16x32_bf16 v[156:159], v[108:111], a[36:39], v[156:159]
    ds_read_b64_tr_b16 a[12:13], v19 offset:0
    v_xor_b32 v20, 8192, v20
    v_mfma_f32_16x16x32_bf16 v[172:175], v[112:115], a[40:43], v[172:175]
    ds_read_b64_tr_b16 a[14:15], v19 offset:2048
    v_xor_b32 v21, 8192, v21
    v_mfma_f32_16x16x32_bf16 v[184:187], v[112:115], a[44:47], v[184:187]
    ds_read_b64_tr_b16 a[0:1], v16 offset:0
    v_mfma_f32_16x16x32_bf16 v[148:151], v[112:115], a[32:35], v[148:151]
    buffer_load_dwordx4 v[64:67], v6, s[40:43], s16 offen offset:1024 sc1
    v_mfma_f32_16x16x32_bf16 v[160:163], v[112:115], a[36:39], v[160:163]
    ds_read_b64_tr_b16 a[2:3], v16 offset:2048
    v_mfma_f32_16x16x32_bf16 v[176:179], v[116:119], a[40:43], v[176:179]
    ds_read_b64_tr_b16 a[4:5], v17 offset:0
    v_mfma_f32_16x16x32_bf16 v[188:191], v[116:119], a[44:47], v[188:191]
    s_waitcnt vmcnt(8)
    ds_read_b64_tr_b16 a[6:7], v17 offset:2048
    v_fma_f32 v8, v123, v127, v131
    v_cmp_u_f32 vcc, v8, v8
    v_mfma_f32_16x16x32_bf16 v[152:155], v[116:119], a[32:35], v[152:155]
    buffer_load_dwordx4 v[68:71], v6, s[40:43], s16 offen offset:2048 sc1
    v_mfma_f32_16x16x32_bf16 v[164:167], v[116:119], a[36:39], v[164:167]
    s_waitcnt lgkmcnt(6)
    s_cbranch_vccnz L_o6_slow
L_o6_ok:
    v_mfma_f32_16x16x32_bf16 v[168:171], v[120:123], a[8:11], v[168:171]
    s_waitcnt lgkmcnt(4)
    ds_read_b64_tr_b16 a[24:25], v22 offset:0
    v_xor_b32 v18, 90112, v18
    v_mfma_f32_16x16x32_bf16 v[180:183], v[120:123], a[12:15], v[180:183]
    s_waitcnt lgkmcnt(3)
    ds_read_b64_tr_b16 a[26:27], v22 offset:2048
    v_xor_b32 v19, 90112, v19
    v_mfma_f32_16x16x32_bf16 v[144:147], v[120:123], a[0:3], v[144:147]
    s_waitcnt lgkmcnt(2)
    buffer_load_dwordx4 v[72:75], v5, s[40:43], s17 offen offset:0 sc1
    v_mfma_f32_16x16x32_bf16 v[156:159], v[120:123], a[4:7], v[156:159]
    ds_read_b64_tr_b16 a[28:29], v23 offset:0
    v_xor_b32 v16, 90112, v16
    v_mfma_f32_16x16x32_bf16 v[172:175], v[124:127], a[8:11], v[172:175]
    ds_read_b64_tr_b16 a[30:31], v23 offset:2048
    v_xor_b32 v17, 90112, v17
    v_mfma_f32_16x16x32_bf16 v[184:187], v[124:127], a[12:15], v[184:187]
    ds_read_b64_tr_b16 a[16:17], v20 offset:0
    v_mfma_f32_16x16x32_bf16 v[148:151], v[124:127], a[0:3], v[148:151]
    buffer_load_dwordx4 v[76:79], v5, s[40:43], s17 offen offset:1024 sc1
    v_mfma_f32_16x16x32_bf16 v[160:163], v[124:127], a[4:7], v[160:163]
    ds_read_b64_tr_b16 a[18:19], v20 offset:2048
    v_mfma_f32_16x16x32_bf16 v[176:179], v[128:131], a[8:11], v[176:179]
    s_barrier
    ds_read_b64_tr_b16 a[20:21], v21 offset:0
    v_mfma_f32_16x16x32_bf16 v[188:191], v[128:131], a[12:15], v[188:191]
    s_waitcnt vmcnt(8)
    ds_read_b64_tr_b16 a[22:23], v21 offset:2048
    v_fma_f32 v8, v135, v139, v143
    v_cmp_u_f32 vcc, v8, v8
    v_mfma_f32_16x16x32_bf16 v[152:155], v[128:131], a[0:3], v[152:155]
    buffer_load_dwordx4 v[80:83], v5, s[40:43], s17 offen offset:2048 sc1
    v_mfma_f32_16x16x32_bf16 v[164:167], v[128:131], a[4:7], v[164:167]
L_pg2:
    s_cbranch_execz L_pgr2
    s_waitcnt lgkmcnt(6)
    s_cbranch_vccnz L_o7_slow
L_o7_ok:
    v_mfma_f32_16x16x32_bf16 v[168:171], v[132:135], a[24:27], v[168:171]
    s_waitcnt lgkmcnt(4)
    ds_read_b64_tr_b16 a[40:41], v18 offset:0
    v_xor_b32 v22, 90112, v22
    v_mfma_f32_16x16x32_bf16 v[180:183], v[132:135], a[28:31], v[180:183]
    s_waitcnt lgkmcnt(3)
    ds_read_b64_tr_b16 a[42:43], v18 offset:2048
    v_xor_b32 v23, 90112, v23
    v_mfma_f32_16x16x32_bf16 v[144:147], v[132:135], a[16:19], v[144:147]
    s_waitcnt lgkmcnt(2)
    buffer_load_dwordx4 v[84:87], v6, s[40:43], s17 offen offset:0 sc1
    v_mfma_f32_16x16x32_bf16 v[156:159], v[132:135], a[20:23], v[156:159]
    ds_read_b64_tr_b16 a[44:45], v19 offset:0
    v_xor_b32 v20, 90112, v20
    v_mfma_f32_16x16x32_bf16 v[172:175], v[136:139], a[24:27], v[172:175]
    ds_read_b64_tr_b16 a[46:47], v19 offset:2048
    v_xor_b32 v21, 90112, v21
    v_mfma_f32_16x16x32_bf16 v[184:187], v[136:139], a[28:31], v[184:187]
    ds_read_b64_tr_b16 a[32:33], v16 offset:0
    v_mfma_f32_16x16x32_bf16 v[148:151], v[136:139], a[16:19], v[148:151]
    buffer_load_dwordx4 v[88:91], v6, s[40:43], s17 offen offset:1024 sc1
    v_mfma_f32_16x16x32_bf16 v[160:163], v[136:139], a[20:23], v[160:163]
    ds_read_b64_tr_b16 a[34:35], v16 offset:2048
    v_mfma_f32_16x16x32_bf16 v[176:179], v[140:143], a[24:27], v[176:179]
    ds_read_b64_tr_b16 a[36:37], v17 offset:0
    v_mfma_f32_16x16x32_bf16 v[188:191], v[140:143], a[28:31], v[188:191]
    s_waitcnt vmcnt(8)
    ds_read_b64_tr_b16 a[38:39], v17 offset:2048
    v_fma_f32 v8, v51, v55, v59
    v_cmp_u_f32 vcc, v8, v8
    v_mfma_f32_16x16x32_bf16 v[152:155], v[140:143], a[16:19], v[152:155]
    buffer_load_dwordx4 v[92:95], v6, s[40:43], s17 offen offset:2048 sc1
    v_mfma_f32_16x16x32_bf16 v[164:167], v[140:143], a[20:23], v[164:167]
    s_waitcnt lgkmcnt(6)
    s_cbranch_vccnz L_o8_slow
L_o8_ok:
    v_mfma_f32_16x16x32_bf16 v[168:171], v[48:51], a[40:43], v[168:171]
    s_waitcnt lgkmcnt(4)
    ds_read_b64_tr_b16 a[8:9], v22 offset:0
    v_xor_b32 v18, 8192, v18
    v_mfma_f32_16x16x32_bf16 v[180:183], v[48:51], a[44:47], v[180:183]
    s_waitcnt lgkmcnt(3)
    ds_read_b64_tr_b16 a[10:11], v22 offset:2048
    v_xor_b32 v19, 8192, v19
    v_mfma_f32_16x16x32_bf16 v[144:147], v[48:51], a[32:35], v[144:147]
    s_waitcnt lgkmcnt(2)
    buffer_load_dwordx4 v[96:99], v5, s[40:43], s18 offen offset:0 sc1
    v_mfma_f32_16x16x32_bf16 v[156:159], v[48:51], a[36:39], v[156:159]
    ds_read_b64_tr_b16 a[12:13], v23 offset:0
    v_xor_b32 v16, 8192, v16
    v_mfma_f32_16x16x32_bf16 v[172:175], v[52:55], a[40:43], v[172:175]
    ds_read_b64_tr_b16 a[14:15], v23 offset:2048
    v_xor_b32 v17, 8192, v17
    v_mfma_f32_16x16x32_bf16 v[184:187], v[52:55], a[44:47], v[184:187]
    ds_read_b64_tr_b16 a[0:1], v20 offset:0
    v_mfma_f32_16x16x32_bf16 v[148:151], v[52:55], a[32:35], v[148:151]
    buffer_load_dwordx4 v[100:103], v5, s[40:43], s18 offen offset:1024 sc1
    v_mfma_f32_16x16x32_bf16 v[160:163], v[52:55], a[36:39], v[160:163]
    ds_read_b64_tr_b16 a[2:3], v20 offset:2048
    v_mfma_f32_16x16x32_bf16 v[176:179], v[56:59], a[40:43], v[176:179]
    ds_read_b64_tr_b16 a[4:5], v21 offset:0
    v_mfma_f32_16x16x32_bf16 v[188:191], v[56:59], a[44:47], v[188:191]
    s_waitcnt vmcnt(8)
    ds_read_b64_tr_b16 a[6:7], v21 offset:2048
    v_fma_f32 v8, v63, v67, v71
    v_cmp_u_f32 vcc, v8, v8
    v_mfma_f32_16x16x32_bf16 v[152:155], v[56:59], a[32:35], v[152:155]
    buffer_load_dwordx4 v[104:107], v5, s[40:43], s18 offen offset:2048 sc1
    v_mfma_f32_16x16x32_bf16 v[164:167], v[56:59], a[36:39], v[164:167]
    s_waitcnt lgkmcnt(6)
    s_cbranch_vccnz L_o9_slow
L_o9_ok:
    v_mfma_f32_16x16x32_bf16 v[168:171], v[60:63], a[8:11], v[168:171]
    s_waitcnt lgkmcnt(4)
    ds_read_b64_tr_b16 a[24:25], v18 offset:0
    v_xor_b32 v22, 8192, v22
    v_mfma_f32_16x16x32_bf16 v[180:183], v[60:63], a[12:15], v[180:183]
    s_waitcnt lgkmcnt(3)
    ds_read_b64_tr_b16 a[26:27], v18 offset:2048
    v_xor_b32 v23, 8192, v23
    v_mfma_f32_16x16x32_bf16 v[144:147], v[60:63], a[0:3], v[144:147]
    s_waitcnt lgkmcnt(2)
    buffer_load_dwordx4 v[108:111], v6, s[40:43], s18 offen offset:0 sc1
    v_mfma_f32_16x16x32_bf16 v[156:159], v[60:63], a[4:7], v[156:159]
    ds_read_b64_tr_b16 a[28:29], v19 offset:0
    v_xor_b32 v20, 8192, v20
    v_mfma_f32_16x16x32_bf16 v[172:175], v[64:67], a[8:11], v[172:175]
    ds_read_b64_tr_b16 a[30:31], v19 offset:2048
    v_xor_b32 v21, 8192, v21
    v_mfma_f32_16x16x32_bf16 v[184:187], v[64:67], a[12:15], v[184:187]
    ds_read_b64_tr_b16 a[16:17], v16 offset:0
    v_mfma_f32_16x16x32_bf16 v[148:151], v[64:67], a[0:3], v[148:151]
    buffer_load_dwordx4 v[112:115], v6, s[40:43], s18 offen offset:1024 sc1
    v_mfma_f32_16x16x32_bf16 v[160:163], v[64:67], a[4:7], v[160:163]
    ds_read_b64_tr_b16 a[18:19], v16 offset:2048
    v_mfma_f32_16x16x32_bf16 v[176:179], v[68:71], a[8:11], v[176:179]
    ds_read_b64_tr_b16 a[20:21], v17 offset:0
    v_mfma_f32_16x16x32_bf16 v[188:191], v[68:71], a[12:15], v[188:191]
    s_waitcnt vmcnt(8)
    ds_read_b64_tr_b16 a[22:23], v17 offset:2048
    v_fma_f32 v8, v75, v79, v83
    v_cmp_u_f32 vcc, v8, v8
    v_mfma_f32_16x16x32_bf16 v[152:155], v[68:71], a[0:3], v[152:155]
    buffer_load_dwordx4 v[116:119], v6, s[40:43], s18 offen offset:2048 sc1
    v_mfma_f32_16x16x32_bf16 v[164:167], v[68:71], a[4:7], v[164:167]
    s_waitcnt lgkmcnt(6)
    s_cbranch_vccnz L_o10_slow
L_o10_ok:
    v_mfma_f32_16x16x32_bf16 v[168:171], v[72:75], a[24:27], v[168:171]
    s_waitcnt lgkmcnt(4)
    ds_read_b64_tr_b16 a[40:41], v22 offset:0
    v_xor_b32 v18, 24576, v18
    v_mfma_f32_16x16x32_bf16 v[180:183], v[72:75], a[28:31], v[180:183]
    s_waitcnt lgkmcnt(3)
    ds_read_b64_tr_b16 a[42:43], v22 offset:2048
    v_xor_b32 v19, 24576, v19
    v_mfma_f32_16x16x32_bf16 v[144:147], v[72:75], a[16:19], v[144:147]
    s_waitcnt lgkmcnt(2)
    buffer_load_dwordx4 v[120:123], v5, s[40:43], s19 offen offset:0 sc1
    v_mfma_f32_16x16x32_bf16 v[156:159], v[72:75], a[20:23], v[156:159]
    ds_read_b64_tr_b16 a[44:45], v23 offset:0
    v_xor_b32 v16, 24576, v16
    v_mfma_f32_16x16x32_bf16 v[172:175], v[76:79], a[24:27], v[172:175]
    ds_read_b64_tr_b16 a[46:47], v23 offset:2048
    v_xor_b32 v17, 24576, v17
    v_mfma_f32_16x16x32_bf16 v[184:187], v[76:79], a[28:31], v[184:187]
    ds_read_b64_tr_b16 a[32:33], v20 offset:0
    v_mfma_f32_16x16x32_bf16 v[148:151], v[76:79], a[16:19], v[148:151]
    buffer_load_dwordx4 v[124:127], v5, s[40:43], s19 offen offset:1024 sc1
    v_mfma_f32_16x16x32_bf16 v[160:163], v[76:79], a[20:23], v[160:163]
    ds_read_b64_tr_b16 a[34:35], v20 offset:2048
    v_mfma_f32_16x16x32_bf16 v[176:179], v[80:83], a[24:27], v[176:179]
    ds_read_b64_tr_b16 a[36:37], v21 offset:0
    v_mfma_f32_16x16x32_bf16 v[188:191], v[80:83], a[28:31], v[188:191]
    s_waitcnt vmcnt(8)
    ds_read_b64_tr_b16 a[38:39], v21 offset:2048
    v_fma_f32 v8, v87, v91, v95
    v_cmp_u_f32 vcc, v8, v8
    v_mfma_f32_16x16x32_bf16 v[152:155], v[80:83], a[16:19], v[152:155]
    buffer_load_dwordx4 v[128:131], v5, s[40:43], s19 offen offset:2048 sc1
    v_mfma_f32_16x16x32_bf16 v[164:167], v[80:83], a[20:23], v[164:167]
    s_waitcnt lgkmcnt(6)
    s_cbranch_vccnz L_o11_slow
L_o11_ok:
    v_mfma_f32_16x16x32_bf16 v[168:171], v[84:87], a[40:43], v[168:171]
    s_waitcnt lgkmcnt(4)
    ds_read_b64_tr_b16 a[8:9], v18 offset:0
    v_xor_b32 v22, 24576, v22
    v_mfma_f32_16x16x32_bf16 v[180:183], v[84:87], a[44:47], v[180:183]
    s_waitcnt lgkmcnt(3)
    ds_read_b64_tr_b16 a[10:11], v18 offset:2048
    v_xor_b32 v23, 24576, v23
    v_mfma_f32_16x16x32_bf16 v[144:147], v[84:87], a[32:35], v[144:147]
    s_waitcnt lgkmcnt(2)
    buffer_load_dwordx4 v[132:135], v6, s[40:43], s19 offen offset:0 sc1
    v_mfma_f32_16x16x32_bf16 v[156:159], v[84:87], a[36:39], v[156:159]
    ds_read_b64_tr_b16 a[12:13], v19 offset:0
    v_xor_b32 v20, 24576, v20
    v_mfma_f32_16x16x32_bf16 v[172:175], v[88:91], a[40:43], v[172:175]
    ds_read_b64_tr_b16 a[14:15], v19 offset:2048
    v_xor_b32 v21, 24576, v21
    v_mfma_f32_16x16x32_bf16 v[184:187], v[88:91], a[44:47], v[184:187]
    ds_read_b64_tr_b16 a[0:1], v16 offset:0
    v_mfma_f32_16x16x32_bf16 v[148:151], v[88:91], a[32:35], v[148:151]
    buffer_load_dwordx4 v[136:139], v6, s[40:43], s19 offen offset:1024 sc1
    v_mfma_f32_16x16x32_bf16 v[160:163], v[88:91], a[36:39], v[160:163]
    ds_read_b64_tr_b16 a[2:3], v16 offset:2048
    v_mfma_f32_16x16x32_bf16 v[176:179], v[92:95], a[40:43], v[176:179]
    ds_read_b64_tr_b16 a[4:5], v17 offset:0
    v_mfma_f32_16x16x32_bf16 v[188:191], v[92:95], a[44:47], v[188:191]
    s_waitcnt vmcnt(8)
    ds_read_b64_tr_b16 a[6:7], v17 offset:2048
    v_fma_f32 v8, v99, v103, v107
    v_cmp_u_f32 vcc, v8, v8
    v_mfma_f32_16x16x32_bf16 v[152:155], v[92:95], a[32:35], v[152:155]
    buffer_load_dwordx4 v[140:143], v6, s[40:43], s19 offen offset:2048 sc1
    v_mfma_f32_16x16x32_bf16 v[164:167], v[92:95], a[36:39], v[164:167]
    s_waitcnt lgkmcnt(6)
    s_cbranch_vccnz L_o12_slow
L_o12_ok:
    v_mfma_f32_16x16x32_bf16 v[168:171], v[96:99], a[8:11], v[168:171]
    s_waitcnt lgkmcnt(4)
    ds_read_b64_tr_b16 a[24:25], v22 offset:0
    v_xor_b32 v18, 8192, v18
    v_mfma_f32_16x16x32_bf16 v[180:183], v[96:99], a[12:15], v[180:183]
    s_waitcnt lgkmcnt(3)
    ds_read_b64_tr_b16 a[26:27], v22 offset:2048
    v_xor_b32 v19, 8192, v19
    v_mfma_f32_16x16x32_bf16 v[144:147], v[96:99], a[0:3], v[144:147]
    s_waitcnt lgkmcnt(2)
    v_mfma_f32_16x16x32_bf16 v[156:159], v[96:99], a[4:7], v[156:159]
    ds_read_b64_tr_b16 a[28:29], v23 offset:0
    v_xor_b32 v16, 8192, v16
    v_mfma_f32_16x16x32_bf16 v[172:175], v[100:103], a[8:11], v[172:175]
    ds_read_b64_tr_b16 a[30:31], v23 offset:2048
    v_xor_b32 v17, 8192, v17
    v_mfma_f32_16x16x32_bf16 v[184:187], v[100:103], a[12:15], v[184:187]
    ds_read_b64_tr_b16 a[16:17], v20 offset:0
    v_mfma_f32_16x16x32_bf16 v[148:151], v[100:103], a[0:3], v[148:151]
    v_mfma_f32_16x16x32_bf16 v[160:163], v[100:103], a[4:7], v[160:163]
    ds_read_b64_tr_b16 a[18:19], v20 offset:2048
    v_mfma_f32_16x16x32_bf16 v[176:179], v[104:107], a[8:11], v[176:179]
    ds_read_b64_tr_b16 a[20:21], v21 offset:0
    ds_read_b64_tr_b16 a[40:41], v18 offset:0
    ds_read_b64_tr_b16 a[42:43], v18 offset:2048
    v_mfma_f32_16x16x32_bf16 v[188:191], v[104:107], a[12:15], v[188:191]
    s_waitcnt vmcnt(6)
    ds_read_b64_tr_b16 a[22:23], v21 offset:2048
    ds_read_b64_tr_b16 a[44:45], v19 offset:0
    v_fma_f32 v8, v111, v115, v119
    v_cmp_u_f32 vcc, v8, v8
    v_mfma_f32_16x16x32_bf16 v[152:155], v[104:107], a[0:3], v[152:155]
    ds_read_b64_tr_b16 a[46:47], v19 offset:2048
    v_xor_b32 v22, 8192, v22
    v_mfma_f32_16x16x32_bf16 v[164:167], v[104:107], a[4:7], v[164:167]
    s_waitcnt lgkmcnt(10)
    s_cbranch_vccnz L_o13_slow
L_o13_ok:
    ds_read_b64_tr_b16 a[32:33], v16 offset:0
    ds_read_b64_tr_b16 a[34:35], v16 offset:2048
    v_xor_b32 v23, 8192, v23
    v_mfma_f32_16x16x32_bf16 v[168:171], v[108:111], a[24:27], v[168:171]
    s_waitcnt lgkmcnt(10)
    ds_read_b64_tr_b16 a[36:37], v17 offset:0
    v_xor_b32 v20, 8192, v20
    v_mfma_f32_16x16x32_bf16 v[180:183], v[108:111], a[28:31], v[180:183]
    ds_read_b64_tr_b16 a[38:39], v17 offset:2048
    v_xor_b32 v21, 8192, v21
    v_mfma_f32_16x16x32_bf16 v[172:175], v[112:115], a[24:27], v[172:175]
    ds_read_b64_tr_b16 a[8:9], v22 offset:0
    ds_read_b64_tr_b16 a[10:11], v22 offset:2048
    v_mfma_f32_16x16x32_bf16 v[184:187], v[112:115], a[28:31], v[184:187]
    s_waitcnt vmcnt(3)
    ds_read_b64_tr_b16 a[12:13], v23 offset:0
    v_fma_f32 v8, v123, v127, v131
    v_cmp_u_f32 vcc, v8, v8
    v_mfma_f32_16x16x32_bf16 v[176:179], v[116:119], a[24:27], v[176:179]
    ds_read_b64_tr_b16 a[14:15], v23 offset:2048
    v_mfma_f32_16x16x32_bf16 v[188:191], v[116:119], a[28:31], v[188:191]
    s_waitcnt lgkmcnt(11)
    s_cbranch_vccnz L_o14_slow
L_o14_ok:
    ds_read_b64_tr_b16 a[0:1], v20 offset:0
    ds_read_b64_tr_b16 a[2:3], v20 offset:2048
    v_mfma_f32_16x16x32_bf16 v[168:171], v[120:123], a[40:43], v[168:171]
    s_waitcnt lgkmcnt(10)
    ds_read_b64_tr_b16 a[4:5], v21 offset:0
    v_mfma_f32_16x16x32_bf16 v[180:183], v[120:123], a[44:47], v[180:183]
    ds_read_b64_tr_b16 a[6:7], v21 offset:2048
    v_mfma_f32_16x16x32_bf16 v[172:175], v[124:127], a[40:43], v[172:175]
    v_mfma_f32_16x16x32_bf16 v[184:187], v[124:127], a[44:47], v[184:187]
    s_waitcnt vmcnt(0)
    v_fma_f32 v8, v135, v139, v143
    v_cmp_u_f32 vcc, v8, v8
    v_mfma_f32_16x16x32_bf16 v[176:179], v[128:131], a[40:43], v[176:179]
    v_mfma_f32_16x16x32_bf16 v[188:191], v[128:131], a[44:47], v[188:191]
    s_waitcnt lgkmcnt(6)
    s_cbranch_vccnz L_o15_slow
L_o15_ok:
    v_mfma_f32_16x16x32_bf16 v[168:171], v[132:135], a[8:11], v[168:171]
    s_waitcnt lgkmcnt(4)
    v_mfma_f32_16x16x32_bf16 v[180:183], v[132:135], a[12:15], v[180:183]
    v_mfma_f32_16x16x32_bf16 v[172:175], v[136:139], a[8:11], v[172:175]
    v_mfma_f32_16x16x32_bf16 v[184:187], v[136:139], a[12:15], v[184:187]
    v_mfma_f32_16x16x32_bf16 v[176:179], v[140:143], a[8:11], v[176:179]
    v_mfma_f32_16x16x32_bf16 v[188:191], v[140:143], a[12:15], v[188:191]
    v_mfma_f32_16x16x32_bf16 v[144:147], v[108:111], a[16:19], v[144:147]
    v_mfma_f32_16x16x32_bf16 v[156:159], v[108:111], a[20:23], v[156:159]
    v_mfma_f32_16x16x32_bf16 v[148:151], v[112:115], a[16:19], v[148:151]
    v_mfma_f32_16x16x32_bf16 v[160:163], v[112:115], a[20:23], v[160:163]
    ds_write_b128 v24, v[168:171] offset:0
    v_mfma_f32_16x16x32_bf16 v[152:155], v[116:119], a[16:19], v[152:155]
    v_mfma_f32_16x16x32_bf16 v[164:167], v[116:119], a[20:23], v[164:167]
    ds_write_b128 v24, v[180:183] offset:3072
    v_mfma_f32_16x16x32_bf16 v[144:147], v[120:123], a[32:35], v[144:147]
    v_mfma_f32_16x16x32_bf16 v[156:159], v[120:123], a[36:39], v[156:159]
    ds_write_b128 v24, v[172:175] offset:1024
    v_mfma_f32_16x16x32_bf16 v[148:151], v[124:127], a[32:35], v[148:151]
    v_mfma_f32_16x16x32_bf16 v[160:163], v[124:127], a[36:39], v[160:163]
    ds_write_b128 v24, v[184:187] offset:4096
    v_mfma_f32_16x16x32_bf16 v[152:155], v[128:131], a[32:35], v[152:155]
    v_mfma_f32_16x16x32_bf16 v[164:167], v[128:131], a[36:39], v[164:167]
    s_waitcnt lgkmcnt(6)
    ds_write_b128 v24, v[176:179] offset:2048
    v_mfma_f32_16x16x32_bf16 v[144:147], v[132:135], a[0:3], v[144:147]
    s_waitcnt lgkmcnt(5)
    v_mfma_f32_16x16x32_bf16 v[156:159], v[132:135], a[4:7], v[156:159]
    ds_write_b128 v24, v[188:191] offset:5120
    v_mfma_f32_16x16x32_bf16 v[148:151], v[136:139], a[0:3], v[148:151]
    v_mfma_f32_16x16x32_bf16 v[160:163], v[136:139], a[4:7], v[160:163]
    v_mfma_f32_16x16x32_bf16 v[152:155], v[140:143], a[0:3], v[152:155]
    v_mfma_f32_16x16x32_bf16 v[164:167], v[140:143], a[4:7], v[164:167]
    s_mov_b32 s65, 262144
    s_waitcnt lgkmcnt(0)
    s_barrier
    ds_read_b128 v[48:51], v25 offset:0
    ds_read_b128 v[52:55], v25 offset:1024
    ds_read_b128 v[56:59], v25 offset:2048
    ds_read_b128 v[60:63], v25 offset:3072
    ds_read_b128 v[64:67], v25 offset:4096
    ds_read_b128 v[68:71], v25 offset:5120
    s_waitcnt lgkmcnt(5)
    v_pk_add_f32 v[146:147], v[146:147], v[50:51]
    s_waitcnt lgkmcnt(4)
    v_pk_add_f32 v[150:151], v[150:151], v[54:55]
    s_waitcnt lgkmcnt(3)
    v_pk_add_f32 v[154:155], v[154:155], v[58:59]
    s_waitcnt lgkmcnt(2)
    v_pk_add_f32 v[158:159], v[158:159], v[62:63]
    s_waitcnt lgkmcnt(1)
    v_pk_add_f32 v[162:163], v[162:163], v[66:67]
    s_waitcnt lgkmcnt(0)
    v_pk_add_f32 v[166:167], v[166:167], v[70:71]
    v_cvt_pk_bf16_f32 v40, v146, v158
    v_cvt_pk_bf16_f32 v41, v150, v162
    v_cvt_pk_bf16_f32 v42, v154, v166
    v_cvt_pk_bf16_f32 v44, v147, v159
    v_cvt_pk_bf16_f32 v45, v151, v163
    v_cvt_pk_bf16_f32 v46, v155, v167
    buffer_store_dwordx4 v[40:43], v2, s[40:43], s33 offen sc1
    buffer_store_dwordx4 v[44:47], v2, s[40:43], s34 offen sc1
    v_pk_add_f32 v[144:145], v[144:145], v[48:49]
    v_pk_add_f32 v[148:149], v[148:149], v[52:53]
    v_pk_add_f32 v[152:153], v[152:153], v[56:57]
    v_pk_add_f32 v[156:157], v[156:157], v[60:61]
    v_pk_add_f32 v[160:161], v[160:161], v[64:65]
    v_pk_add_f32 v[164:165], v[164:165], v[68:69]
    v_cvt_pk_bf16_f32 v36, v145, v157
    v_cvt_pk_bf16_f32 v37, v149, v161
    v_cvt_pk_bf16_f32 v38, v153, v165
    buffer_store_dwordx4 v[36:39], v2, s[40:43], s32 offen sc1
    v_and_b32 v13, 1, v1
    v_mul_u32_u24 v12, 30, v13
    v_lshl_add_u32 v12, v7, 1, v12
    v_mul_u32_u24 v13, 0x0606, v13
    v_lshl_or_b32 v13, v13, 16, v13
    v_xor_b32 v30, 0x01000504, v13
    v_lshl_add_u32 v26, v4, 13, v12
    v_add_u32 v27, 32768, v26
    v_add_u32 v28, 65536, v26
    buffer_load_dwordx4 v[80:83], v2, s[40:43], s96 offen sc1
    buffer_load_dwordx4 v[84:87], v2, s[40:43], s97 offen sc1
    buffer_load_dwordx4 v[88:91], v2, s[40:43], s98 offen sc1
    v_mov_b32 v145, v156
    v_mov_b32 v149, v160
    v_mov_b32 v153, v164
    s_mov_b32 s60, 0xffff0000
    s_branch L_f_chk
L_f_again:
    s_cmp_eq_u32 s65, 0
    s_cbranch_scc1 L_f_ok
    s_sub_u32 s65, s65, 1
    buffer_load_dwordx4 v[80:83], v2, s[40:43], s96 offen sc1
    buffer_load_dwordx4 v[84:87], v2, s[40:43], s97 offen sc1
    buffer_load_dwordx4 v[88:91], v2, s[40:43], s98 offen sc1
L_f_chk:
    s_waitcnt vmcnt(0)
    v_min3_u32 v8, v83, v87, v91
    v_max3_u32 v15, v83, v87, v91
    v_cmp_ne_u32 s[68:69], s55, v8
    v_cmp_ne_u32 vcc, s55, v15
    s_nop 1
    s_or_b64 vcc, vcc, s[68:69]
    s_cbranch_scc1 L_f_again
L_f_ok:
    v_lshlrev_b32 v48, 16, v80
    v_and_b32 v49, s60, v80
    v_lshlrev_b32 v50, 16, v81
    v_and_b32 v51, s60, v81
    v_lshlrev_b32 v52, 16, v82
    v_and_b32 v53, s60, v82
    v_pk_add_f32 v[144:145], v[144:145], v[48:49]
    v_pk_add_f32 v[148:149], v[148:149], v[50:51]
    v_pk_add_f32 v[152:153], v[152:153], v[52:53]
    v_lshlrev_b32 v48, 16, v84
    v_and_b32 v49, s60, v84
    v_lshlrev_b32 v50, 16, v85
    v_and_b32 v51, s60, v85
    v_lshlrev_b32 v52, 16, v86
    v_and_b32 v53, s60, v86
    v_pk_add_f32 v[144:145], v[144:145], v[48:49]
    v_pk_add_f32 v[148:149], v[148:149], v[50:51]
    v_pk_add_f32 v[152:153], v[152:153], v[52:53]
    v_lshlrev_b32 v48, 16, v88
    v_and_b32 v49, s60, v88
    v_lshlrev_b32 v50, 16, v89
    v_and_b32 v51, s60, v89
    v_lshlrev_b32 v52, 16, v90
    v_and_b32 v53, s60, v90
    v_pk_add_f32 v[144:145], v[144:145], v[48:49]
    v_pk_add_f32 v[148:149], v[148:149], v[50:51]
    v_pk_add_f32 v[152:153], v[152:153], v[52:53]
    v_cvt_pk_bf16_f32 v56, v144, v145
    v_cvt_pk_bf16_f32 v57, v148, v149
    v_cvt_pk_bf16_f32 v58, v152, v153
    v_mov_b32_dpp v60, v56 quad_perm:[1,0,3,2] row_mask:0xf bank_mask:0xf
    v_mov_b32_dpp v61, v57 quad_perm:[1,0,3,2] row_mask:0xf bank_mask:0xf
    v_mov_b32_dpp v62, v58 quad_perm:[1,0,3,2] row_mask:0xf bank_mask:0xf
    v_perm_b32 v56, v56, v60, v30
    v_perm_b32 v57, v57, v61, v30
    v_perm_b32 v58, v58, v62, v30
    buffer_store_dword v56, v26, s[44:47], s4 offen
    buffer_store_dword v57, v27, s[44:47], s4 offen
    buffer_store_dword v58, v28, s[44:47], s4 offen
    s_or_b32 s54, s54, s52
    s_or_b32 s60, s54, s49
    s_cmp_lg_u32 s60, 0
    s_cbranch_scc1 L_fin
    s_lshl_b32 s60, s50, 7
    v_mov_b32 v8, s11
    v_mov_b32 v9, 0
    s_mov_b64 exec, 1
    buffer_store_dword v8, v9, s[40:43], s60 offen sc1
    s_mov_b64 exec, -1
L_fin:
L_end:
L_last:
    s_endpgm
.section .rodata,"a"
.p2align 6
.amdhsa_kernel standalone__gqa_block_cached__near_ridge_kernel
  .amdhsa_next_free_vgpr 256
  .amdhsa_next_free_sgpr 102
  .amdhsa_accum_offset 200
  .amdhsa_group_segment_fixed_size 0
  .amdhsa_kernarg_size 64
  .amdhsa_user_sgpr_count 2
  .amdhsa_user_sgpr_kernarg_segment_ptr 1
  .amdhsa_system_sgpr_workgroup_id_x 1
.end_amdhsa_kernel
```
